```python
import torch

def _softmax(x, axis=-1):
    return torch.softmax(x, dim=axis)

def _gelu(x):
    return torch.nn.functional.gelu(x, approximate='tanh')

def _silu(x):
    return torch.nn.functional.silu(x)

def _sigmoid(x):
    return torch.sigmoid(x)

def _layernorm(x, axis=-1, eps=1e-05):
    m = x.mean(dim=axis, keepdim=True)
    v = x.var(dim=axis, keepdim=True, unbiased=False)
    return (x - m) / torch.sqrt(v + eps)

def _scatter_add(tgt, idx, src, axis=0):
    return tgt.clone().index_add_(axis, idx, src)

def _segment_sum(src, seg, n):
    out = torch.zeros((n,) + src.shape[1:], dtype=src.dtype)
    return out.index_add_(0, seg, src)

def _pad(x, pw):
    flat = tuple((v for pair in reversed(pw) for v in pair))
    return torch.nn.functional.pad(x, flat)
kernel_name = 'adaLN_cond__gqa_block_cached__glu_gated_geglu__decode'

def setup_inputs():

    _w = lambda a: (lambda t: t.to(torch.bfloat16) if t.is_floating_point() else t)(torch.as_tensor(a))

    def _A_setup():
        B, Sq, D = (1, 1, 640)
        Hq, Hkv, Sk, Dh = (32, 32, 4096, 128)
        assert Hq % Hkv == 0, (Hq, Hkv)
        return {'x': _w((lambda *s: torch.randn(*s, dtype=torch.bfloat16) * 0.05)(B, Sq, D)), 'k_cache': _w((lambda *s: torch.randn(*s, dtype=torch.bfloat16) * 3.2)(B, Hkv, Sk, Dh)), 'v_cache': _w((lambda *s: torch.randn(*s, dtype=torch.bfloat16) * 3.2)(B, Hkv, Sk, Dh)), 'wq': _w((lambda *s: torch.randn(*s, dtype=torch.bfloat16) * 3.2)(D, Hq * Dh) * D ** (-0.5)), 'wo': _w((lambda *s: torch.randn(*s, dtype=torch.bfloat16) * 3.2)(Hq * Dh, D) * (Hq * Dh) ** (-0.5))}
    _A_in = _A_setup()

    def _B_setup():
        B, S, Dm, Df = (1, 1, 640, 1728)
        return {'x': _w((lambda *s: torch.randn(*s, dtype=torch.bfloat16) * 0.05)(B, S, Dm)), 'w_gate': _w((lambda *s: torch.randn(*s, dtype=torch.bfloat16) * 3.2)(Dm, Df) * Dm ** (-0.5)), 'w_up': _w((lambda *s: torch.randn(*s, dtype=torch.bfloat16) * 3.2)(Dm, Df) * Dm ** (-0.5)), 'w_down': _w((lambda *s: torch.randn(*s, dtype=torch.bfloat16) * 3.2)(Df, Dm) * Df ** (-0.5))}
    _B_in = _B_setup()
    return {'A_x': _A_in['x'], 'A_k_cache': _A_in['k_cache'], 'A_v_cache': _A_in['v_cache'], 'A_wq': _A_in['wq'], 'A_wo': _A_in['wo'], 'B_x': _B_in['x'], 'B_w_gate': _B_in['w_gate'], 'B_w_up': _B_in['w_up'], 'B_w_down': _B_in['w_down'], 'c': _w((lambda *s: torch.randn(*s, dtype=torch.bfloat16) * 0.1)(1, 640) * 8.0), 'w_mod': _w((lambda *s: torch.randn(*s, dtype=torch.bfloat16) * 0.1)(640, 6 * 640) * 640 ** (-0.5) * 8.0)}

def reference(A_x, A_k_cache, A_v_cache, A_wq, A_wo, B_x, B_w_gate, B_w_up, B_w_down, c, w_mod):

    def _A_ref(x, k_cache, v_cache, wq, wo):
        B, Sq, D = x.shape
        Hq, Dh = (32, 128)
        Hkv = k_cache.shape[1]
        rep = Hq // Hkv
        q = (lambda x, *d: x.permute(*d))((x @ wq).reshape(B, Sq, Hq, Dh), 0, 2, 1, 3)
        k = (lambda x, n, axis: torch.repeat_interleave(x, n, dim=axis))(k_cache, rep, axis=1)
        v = (lambda x, n, axis: torch.repeat_interleave(x, n, dim=axis))(v_cache, rep, axis=1)
        scores = torch.einsum('bhqd,bhkd->bhqk', q, k) * Dh ** (-0.5)
        p = _softmax(scores, axis=-1)
        o = torch.einsum('bhqk,bhkd->bhqd', p, v)
        return (lambda x, *d: x.permute(*d))(o, 0, 2, 1, 3).reshape(B, Sq, Hq * Dh) @ wo

    def _B_ref(x, w_gate, w_up, w_down):
        g = torch.einsum('bsd,df->bsf', x, w_gate)
        u = torch.einsum('bsd,df->bsf', x, w_up)
        h = _gelu(g) * u
        return torch.einsum('bsf,fd->bsd', h, w_down)
    x = A_x
    mod = (_silu(c) @ w_mod).reshape(c.shape[0], 6, 1, -1)
    sa, ca, ga, sb, cb, gb = (mod[:, 0].clone(), mod[:, 1].clone(), mod[:, 2].clone(), mod[:, 3].clone(), mod[:, 4].clone(), mod[:, 5].clone())
    h = _layernorm(x, axis=-1) * (1 + ca) + sa
    x = x + ga * _A_ref(h, A_k_cache, A_v_cache, A_wq, A_wo)
    h = _layernorm(x, axis=-1) * (1 + cb) + sb
    x = x + gb * _B_ref(h, B_w_gate, B_w_up, B_w_down)
    return x
```

```asm
; @launch grid=(256,1,1) block=(1024,1,1) lds=26112
.amdgcn_target "amdgcn-amd-amdhsa--gfx950"
.text
.globl adaLN_cond__gqa_block_cached__glu_gated_geglu__decode_kernel
.p2align 8
.type adaLN_cond__gqa_block_cached__glu_gated_geglu__decode_kernel,@function
adaLN_cond__gqa_block_cached__glu_gated_geglu__decode_kernel:
    s_cmp_ge_u32 s2, 256
    s_cbranch_scc1 L_end
    s_load_dwordx16 s[4:19], s[0:1], 0
    s_load_dwordx8 s[20:27], s[0:1], 64
    s_load_dwordx4 s[28:31], s[0:1], 96
    v_lshrrev_b32 v1, 6, v0
    v_and_b32 v0, 63, v0
    v_readfirstlane_b32 s33, v1
    v_lshlrev_b32 v3, 4, v0
    v_and_b32 v1, 15, v0
    v_lshrrev_b32 v2, 4, v0
    v_mov_b32 v4, 0
    s_cmp_lg_u32 s33, 15
    s_cbranch_scc1 L_noinit
    s_getpc_b64 s[36:37]
L_pc:
    s_sub_u32 s36, s36, L_pc-adaLN_cond__gqa_block_cached__glu_gated_geglu__decode_kernel
    s_subb_u32 s37, s37, 0
    v_lshlrev_b32 v5, 7, v0
    v_add_u32 v6, 8192, v5
    v_add_u32 v7, 16384, v5
    v_min_u32 v6, L_end-adaLN_cond__gqa_block_cached__glu_gated_geglu__decode_kernel, v6
    v_min_u32 v7, L_end-adaLN_cond__gqa_block_cached__glu_gated_geglu__decode_kernel, v7
    s_sub_u32 s3, s2, 32
    s_cmp_ge_u32 s3, 32
    s_cbranch_scc1 L_nopf
    global_load_dword v11, v5, s[36:37]
    global_load_dword v11, v6, s[36:37]
    global_load_dword v11, v7, s[36:37]
L_nopf:
    v_lshlrev_b32 v5, 2, v0
    ds_write_b32 v5, v4
    s_waitcnt lgkmcnt(0)
L_noinit:
    s_cmp_lt_u32 s2, 64
    s_cbranch_scc1 L_service
    s_sub_u32 s3, s2, 64
    s_mul_i32 s34, s3, 10923
    s_lshr_b32 s34, s34, 16
    s_mul_i32 s35, s34, 6
    s_sub_u32 s35, s3, s35
    s_mul_i32 s40, s35, 11185152
    s_lshr_b32 s40, s40, 16
    s_add_u32 s41, s35, 1
    s_mul_i32 s41, s41, 11185152
    s_lshr_b32 s41, s41, 16
    s_sub_u32 s32, s41, s40
    s_lshl_b32 s41, s34, 20
    s_lshl_b32 s40, s40, 10
    s_add_u32 s41, s41, s40
    s_lshl_b32 s38, s32, 10
    s_mov_b32 s39, 0x20000
    s_cmp_ge_u32 s33, 8
    s_cbranch_scc1 L_vwave
    s_lshl_b32 s40, s33, 10
    s_waitcnt lgkmcnt(0)
    s_add_u32 s36, s6, s41
    s_addc_u32 s37, s7, 0
    s_cmp_gt_u32 s33, 3
    s_cbranch_scc1 L_kissB
    buffer_load_dwordx4 v[8:11], v3, s[36:39], s40 offen nt
    s_addk_i32 s40, 8192
    buffer_load_dwordx4 v[12:15], v3, s[36:39], s40 offen nt
    s_addk_i32 s40, 8192
    buffer_load_dwordx4 v[16:19], v3, s[36:39], s40 offen nt
    s_addk_i32 s40, 8192
    buffer_load_dwordx4 v[20:23], v3, s[36:39], s40 offen nt
    s_addk_i32 s40, 8192
    s_barrier
    s_waitcnt vmcnt(3)
    buffer_load_dwordx4 v[24:27], v3, s[36:39], s40 offen nt
    s_addk_i32 s40, 8192
    s_waitcnt vmcnt(3)
    buffer_load_dwordx4 v[28:31], v3, s[36:39], s40 offen nt
    s_addk_i32 s40, 8192
    s_waitcnt vmcnt(3)
    buffer_load_dwordx4 v[32:35], v3, s[36:39], s40 offen nt
    s_addk_i32 s40, 8192
    s_waitcnt vmcnt(3)
    buffer_load_dwordx4 v[36:39], v3, s[36:39], s40 offen nt
    s_addk_i32 s40, 8192
    s_waitcnt vmcnt(3)
    buffer_load_dwordx4 v[40:43], v3, s[36:39], s40 offen nt
    s_addk_i32 s40, 8192
    s_waitcnt vmcnt(3)
    buffer_load_dwordx4 v[44:47], v3, s[36:39], s40 offen nt
    s_addk_i32 s40, 8192
    s_waitcnt vmcnt(3)
    buffer_load_dwordx4 v[48:51], v3, s[36:39], s40 offen nt
    s_addk_i32 s40, 8192
    s_waitcnt vmcnt(3)
    buffer_load_dwordx4 v[52:55], v3, s[36:39], s40 offen nt
    s_addk_i32 s40, 8192
    s_waitcnt vmcnt(3)
    buffer_load_dwordx4 v[56:59], v3, s[36:39], s40 offen nt
    s_addk_i32 s40, 8192
    s_waitcnt vmcnt(3)
    buffer_load_dwordx4 v[60:63], v3, s[36:39], s40 offen nt
    s_addk_i32 s40, 8192
    s_waitcnt vmcnt(3)
    buffer_load_dwordx4 v[64:67], v3, s[36:39], s40 offen nt
    s_addk_i32 s40, 8192
    s_waitcnt vmcnt(3)
    buffer_load_dwordx4 v[68:71], v3, s[36:39], s40 offen nt
    s_addk_i32 s40, 8192
    s_waitcnt vmcnt(3)
    buffer_load_dwordx4 v[72:75], v3, s[36:39], s40 offen nt
    s_addk_i32 s40, 8192
    s_waitcnt vmcnt(3)
    buffer_load_dwordx4 v[76:79], v3, s[36:39], s40 offen nt
    s_addk_i32 s40, 8192
    s_waitcnt vmcnt(3)
    buffer_load_dwordx4 v[80:83], v3, s[36:39], s40 offen nt
    s_addk_i32 s40, 8192
    s_waitcnt vmcnt(3)
    buffer_load_dwordx4 v[84:87], v3, s[36:39], s40 offen nt
    s_addk_i32 s40, 8192
    s_waitcnt vmcnt(3)
    buffer_load_dwordx4 v[88:91], v3, s[36:39], s40 offen nt
    s_addk_i32 s40, 8192
    s_waitcnt vmcnt(3)
    buffer_load_dwordx4 v[92:95], v3, s[36:39], s40 offen nt
    v_mov_b32 v5, 1
    s_mov_b64 exec, 1
    ds_add_u32 v4, v5 offset:44
    s_mov_b64 exec, -1
    s_branch L_kiss_done
L_mtile:
    s_mul_i32 s42, s3, 3277
    s_lshr_b32 s42, s42, 16
    s_mul_i32 s43, s42, 20
    s_sub_u32 s43, s3, s43
    s_cmp_ge_u32 s42, 8
    s_cbranch_scc1 L_vwave1
    s_setprio 3
    s_mov_b32 s50, 4915200
    s_mov_b32 s51, 0x20000
    s_mul_i32 s40, s42, 614400
    v_lshrrev_b32 v58, 3, v0
    v_and_b32 v59, 7, v0
    v_mul_u32_u24 v5, 76800, v58
    v_lshl_add_u32 v5, v59, 4, v5
    s_mul_i32 s2, s42, 160
    v_lshl_add_u32 v6, v0, 1, s2
    s_lshl_b32 s2, s43, 7
    s_add_u32 s40, s40, s2
    s_mul_i32 s60, s42, 5120
    s_lshl_b32 s2, s43, 8
    s_add_u32 s60, s60, s2
    s_add_u32 s60, s60, 0
    v_mov_b32 v54, -1
    v_lshlrev_b32 v57, 2, v0
    s_mov_b32 s54, 1280
    s_mov_b32 s55, 0x20000
    s_waitcnt lgkmcnt(0)
    s_mov_b32 s48, s24
    s_mov_b32 s49, s25
    s_mov_b32 s52, s22
    s_mov_b32 s53, s23
    s_mov_b32 s44, s30
    s_mov_b32 s45, s31
    s_mov_b32 s46, 270848
    s_mov_b32 s47, 0x20000
    buffer_load_ushort v48, v6, s[52:55], 0 offen
    buffer_load_ushort v49, v6, s[52:55], 0 offen offset:128
    buffer_load_dwordx4 v[8:11], v5, s[48:51], s40 offen nt
    s_addk_i32 s40, 7680
    buffer_load_dwordx4 v[12:15], v5, s[48:51], s40 offen nt
    s_addk_i32 s40, 7680
    buffer_load_dwordx4 v[16:19], v5, s[48:51], s40 offen nt
    s_addk_i32 s40, 7680
    buffer_load_dwordx4 v[20:23], v5, s[48:51], s40 offen nt
    s_addk_i32 s40, 7680
    buffer_load_dwordx4 v[24:27], v5, s[48:51], s40 offen nt
    s_addk_i32 s40, 7680
    buffer_load_dwordx4 v[28:31], v5, s[48:51], s40 offen nt
    s_addk_i32 s40, 7680
    buffer_load_dwordx4 v[32:35], v5, s[48:51], s40 offen nt
    s_addk_i32 s40, 7680
    buffer_load_dwordx4 v[36:39], v5, s[48:51], s40 offen nt
    s_addk_i32 s40, 7680
    buffer_load_dwordx4 v[40:43], v5, s[48:51], s40 offen nt
    s_addk_i32 s40, 7680
    buffer_load_dwordx4 v[44:47], v5, s[48:51], s40 offen nt
    buffer_store_dword v54, v57, s[44:47], s60 offen sc1
    s_barrier
    s_load_dword s61, s[30:31], 44032
    s_branch L_sec_mt_8
L_service:
    s_barrier
    s_sub_u32 s34, s2, 0
    s_mov_b32 s35, s33
    s_lshl_b32 s41, s34, 8
    s_add_u32 s41, s41, 45056
    s_mov_b32 s39, 0x20000
    s_cmp_ge_u32 s34, 32
    s_cbranch_scc1 L_svcB
    s_cmp_ge_u32 s33, 10
    s_cbranch_scc1 L_hw
    v_lshlrev_b32 v72, 13, v2
    v_lshl_add_u32 v72, v1, 4, v72
    s_mul_i32 s40, s33, 524288
    s_lshl_b32 s2, s34, 8
    s_add_u32 s40, s40, s2
    s_mov_b32 s38, 5242880
    s_waitcnt lgkmcnt(0)
    s_mov_b32 s36, s10
    s_mov_b32 s37, s11
    buffer_load_dwordx4 v[8:11], v72, s[36:39], s40 offen nt
    s_add_u32 s40, s40, 32768
    buffer_load_dwordx4 v[12:15], v72, s[36:39], s40 offen nt
    s_add_u32 s40, s40, 32768
    buffer_load_dwordx4 v[16:19], v72, s[36:39], s40 offen nt
    s_add_u32 s40, s40, 32768
    buffer_load_dwordx4 v[20:23], v72, s[36:39], s40 offen nt
    s_add_u32 s40, s40, 32768
    buffer_load_dwordx4 v[24:27], v72, s[36:39], s40 offen nt
    s_add_u32 s40, s40, 32768
    buffer_load_dwordx4 v[28:31], v72, s[36:39], s40 offen nt
    s_add_u32 s40, s40, 32768
    buffer_load_dwordx4 v[32:35], v72, s[36:39], s40 offen nt
    s_add_u32 s40, s40, 32768
    buffer_load_dwordx4 v[36:39], v72, s[36:39], s40 offen nt
    s_add_u32 s40, s40, 32768
    buffer_load_dwordx4 v[40:43], v72, s[36:39], s40 offen nt
    s_add_u32 s40, s40, 32768
    buffer_load_dwordx4 v[44:47], v72, s[36:39], s40 offen nt
    s_add_u32 s40, s40, 32768
    buffer_load_dwordx4 v[48:51], v72, s[36:39], s40 offen nt
    s_add_u32 s40, s40, 32768
    buffer_load_dwordx4 v[52:55], v72, s[36:39], s40 offen nt
    s_add_u32 s40, s40, 32768
    buffer_load_dwordx4 v[56:59], v72, s[36:39], s40 offen nt
    s_add_u32 s40, s40, 32768
    buffer_load_dwordx4 v[60:63], v72, s[36:39], s40 offen nt
    s_add_u32 s40, s40, 32768
    buffer_load_dwordx4 v[64:67], v72, s[36:39], s40 offen nt
    s_add_u32 s40, s40, 32768
    buffer_load_dwordx4 v[68:71], v72, s[36:39], s40 offen nt
    s_branch L_sec_svc1_13
L_svcB:
    s_sub_u32 s34, s34, 32
    v_lshlrev_b32 v14, 2, v0
    v_mov_b32 v15, 0
    s_cmp_ge_u32 s33, 10
    s_cbranch_scc1 L_clrw
    v_lshrrev_b32 v8, 3, v0
    v_and_b32 v9, 7, v0
    s_mov_b32 s60, s34
    s_cmp_ge_u32 s34, 30
    s_cbranch_scc1 L_fin
    s_waitcnt lgkmcnt(0)
    s_mov_b32 s44, s30
    s_mov_b32 s45, s31
    s_mov_b32 s46, 270848
    s_mov_b32 s47, 0x20000
    v_and_b32 v10, 1, v0
    v_lshlrev_b32 v10, 4, v10
    v_mov_b32 v11, 0xffff
    v_lshlrev_b32 v11, v10, v11
    v_bfe_u32 v10, v0, 1, 2
    v_cmp_eq_u32 vcc, 0, v10
    s_nop 1
    v_cndmask_b32 v4, 0, v11, vcc
    v_cmp_eq_u32 vcc, 1, v10
    s_nop 1
    v_cndmask_b32 v5, 0, v11, vcc
    v_cmp_eq_u32 vcc, 2, v10
    s_nop 1
    v_cndmask_b32 v6, 0, v11, vcc
    v_cmp_eq_u32 vcc, 3, v10
    s_nop 1
    v_cndmask_b32 v7, 0, v11, vcc
    s_branch L_mblk0
L_clrw:
    s_setprio 3
    v_mov_b32 v52, -1
    v_mov_b32 v53, -1
    v_mov_b32 v54, -1
    v_mov_b32 v55, -1
    s_mul_i32 s42, s34, 6
    s_add_u32 s42, s42, s33
    s_mul_i32 s42, s42, 1280
    s_add_u32 s42, s42, 32256
    s_waitcnt lgkmcnt(0)
    s_mov_b32 s44, s30
    s_mov_b32 s45, s31
    s_mov_b32 s46, 270848
    s_mov_b32 s47, 0x20000
    s_load_dword s61, s[30:31], 44032
    buffer_store_dwordx4 v[52:55], v3, s[44:47], s42 offen sc1
    buffer_store_dword v52, v14, s[44:47], s42 offen offset:1024 sc1
    s_waitcnt vmcnt(0)
    v_mov_b32 v53, 1
    s_mov_b64 exec, 1
    ds_add_u32 v15, v53 offset:16
    s_mov_b64 exec, -1
    s_setprio 0
    s_cmp_eq_u32 s33, 15
    s_cbranch_scc1 L_clear
    s_branch L_dwave
L_hw:
    s_setprio 3
    v_mov_b32 v15, 0
    s_mov_b32 s54, 1280
    s_mov_b32 s55, 0x20000
    v_mul_u32_u24 v49, 20, v0
    v_lshl_add_u32 v50, v1, 2, v2
    s_sub_u32 s35, s33, 10
    s_lshl_b32 s2, s35, 7
    v_add_u32 v50, s2, v50
    v_lshlrev_b32 v51, 1, v50
    s_waitcnt lgkmcnt(0)
    s_mov_b32 s52, s4
    s_mov_b32 s53, s5
    s_mov_b32 s44, s30
    s_mov_b32 s45, s31
    s_mov_b32 s46, 270848
    s_mov_b32 s47, 0x20000
    s_load_dword s61, s[30:31], 44032
    s_cmp_eq_u32 s33, 15
    s_cbranch_scc1 L_echk
    buffer_load_dwordx4 v[56:59], v49, s[52:55], 0 offen
    buffer_load_dword v60, v49, s[52:55], 0 offen offset:16
    buffer_load_ushort v61, v51, s[52:55], 0 offen
    buffer_load_ushort v62, v51, s[52:55], 0 offen offset:128
    s_branch L_sec_svc1b_18
L_clear:
    s_mov_b32 s3, 0
L_lw_29:
    ds_read_b32 v53, v15 offset:16
    s_add_u32 s3, s3, 1
    s_cmp_gt_u32 s3, 4194304
    s_cbranch_scc1 L_fin
    s_waitcnt lgkmcnt(0)
    v_readfirstlane_b32 s2, v53
    s_cmp_eq_u32 s2, 6
    s_cbranch_scc0 L_lw_29
    s_add_u32 s98, s61, 2654435769
    s_mov_b32 s99, s98
    s_lshl_b32 s2, s34, 2
    s_add_u32 s2, s2, 43008
    s_atomic_swap s98, s[30:31], s2 offset:0
    s_atomic_swap s98, s[30:31], s2 offset:128
    s_atomic_swap s98, s[30:31], s2 offset:256
    s_atomic_swap s98, s[30:31], s2 offset:384
    s_atomic_swap s98, s[30:31], s2 offset:512
    s_atomic_swap s98, s[30:31], s2 offset:640
    s_atomic_swap s98, s[30:31], s2 offset:768
    s_atomic_swap s98, s[30:31], s2 offset:896
    s_waitcnt lgkmcnt(0)
    s_branch L_sec_svc2_30
L_kissB:
    s_barrier
    s_mov_b32 s3, 0
L_lw_1:
    ds_read_b32 v5, v4 offset:44
    s_add_u32 s3, s3, 1
    s_cmp_gt_u32 s3, 4194304
    s_cbranch_scc1 L_fin
    s_waitcnt lgkmcnt(0)
    v_readfirstlane_b32 s2, v5
    s_cmp_ge_u32 s2, 4
    s_cbranch_scc1 L_lw_1_ok
    s_sleep 1
    s_branch L_lw_1
L_lw_1_ok:
    buffer_load_dwordx4 v[8:11], v3, s[36:39], s40 offen nt
    s_addk_i32 s40, 8192
    buffer_load_dwordx4 v[12:15], v3, s[36:39], s40 offen nt
    s_addk_i32 s40, 8192
    buffer_load_dwordx4 v[16:19], v3, s[36:39], s40 offen nt
    s_addk_i32 s40, 8192
    buffer_load_dwordx4 v[20:23], v3, s[36:39], s40 offen nt
    s_addk_i32 s40, 8192
    buffer_load_dwordx4 v[24:27], v3, s[36:39], s40 offen nt
    s_addk_i32 s40, 8192
    buffer_load_dwordx4 v[28:31], v3, s[36:39], s40 offen nt
    s_addk_i32 s40, 8192
    s_waitcnt vmcnt(5)
    buffer_load_dwordx4 v[32:35], v3, s[36:39], s40 offen nt
    s_addk_i32 s40, 8192
    s_waitcnt vmcnt(5)
    buffer_load_dwordx4 v[36:39], v3, s[36:39], s40 offen nt
    s_addk_i32 s40, 8192
    s_waitcnt vmcnt(5)
    buffer_load_dwordx4 v[40:43], v3, s[36:39], s40 offen nt
    s_addk_i32 s40, 8192
    s_waitcnt vmcnt(5)
    buffer_load_dwordx4 v[44:47], v3, s[36:39], s40 offen nt
    s_addk_i32 s40, 8192
    s_waitcnt vmcnt(5)
    buffer_load_dwordx4 v[48:51], v3, s[36:39], s40 offen nt
    s_addk_i32 s40, 8192
    s_waitcnt vmcnt(5)
    buffer_load_dwordx4 v[52:55], v3, s[36:39], s40 offen nt
    s_addk_i32 s40, 8192
    s_waitcnt vmcnt(5)
    buffer_load_dwordx4 v[56:59], v3, s[36:39], s40 offen nt
    s_addk_i32 s40, 8192
    s_waitcnt vmcnt(5)
    buffer_load_dwordx4 v[60:63], v3, s[36:39], s40 offen nt
    s_addk_i32 s40, 8192
    s_waitcnt vmcnt(5)
    buffer_load_dwordx4 v[64:67], v3, s[36:39], s40 offen nt
    s_addk_i32 s40, 8192
    s_waitcnt vmcnt(5)
    buffer_load_dwordx4 v[68:71], v3, s[36:39], s40 offen nt
    s_addk_i32 s40, 8192
    s_waitcnt vmcnt(5)
    buffer_load_dwordx4 v[72:75], v3, s[36:39], s40 offen nt
    s_addk_i32 s40, 8192
    s_waitcnt vmcnt(5)
    buffer_load_dwordx4 v[76:79], v3, s[36:39], s40 offen nt
    s_addk_i32 s40, 8192
    s_waitcnt vmcnt(5)
    buffer_load_dwordx4 v[80:83], v3, s[36:39], s40 offen nt
    s_addk_i32 s40, 8192
    s_waitcnt vmcnt(5)
    buffer_load_dwordx4 v[84:87], v3, s[36:39], s40 offen nt
    s_addk_i32 s40, 8192
    s_waitcnt vmcnt(5)
    buffer_load_dwordx4 v[88:91], v3, s[36:39], s40 offen nt
    s_addk_i32 s40, 8192
    s_waitcnt vmcnt(5)
    buffer_load_dwordx4 v[92:95], v3, s[36:39], s40 offen nt
    v_mov_b32 v5, 1
    s_mov_b64 exec, 1
    ds_add_u32 v4, v5 offset:44
    s_mov_b64 exec, -1
    s_branch L_kiss_done
L_vwave:
    s_cmp_eq_u32 s33, 8
    s_cbranch_scc1 L_mtile
L_vwave1:
    s_barrier
L_vwave2:
    s_sub_u32 s42, s33, 8
    s_lshl_b32 s40, s42, 10
    s_waitcnt lgkmcnt(0)
    s_add_u32 s36, s8, s41
    s_addc_u32 s37, s9, 0
    v_mov_b32 v4, 0
    s_mov_b32 s3, 0
L_lw_6:
    ds_read_b32 v5, v4 offset:44
    s_add_u32 s3, s3, 1
    s_cmp_gt_u32 s3, 4194304
    s_cbranch_scc1 L_fin
    s_waitcnt lgkmcnt(0)
    v_readfirstlane_b32 s2, v5
    s_cmp_eq_u32 s2, 8
    s_cbranch_scc1 L_lw_6_ok
    s_sleep 2
    s_branch L_lw_6
L_lw_6_ok:
    buffer_load_dwordx4 v[8:11], v3, s[36:39], s40 offen nt
    s_addk_i32 s40, 8192
    buffer_load_dwordx4 v[12:15], v3, s[36:39], s40 offen nt
    s_addk_i32 s40, 8192
    buffer_load_dwordx4 v[16:19], v3, s[36:39], s40 offen nt
    s_addk_i32 s40, 8192
    buffer_load_dwordx4 v[20:23], v3, s[36:39], s40 offen nt
    s_addk_i32 s40, 8192
    buffer_load_dwordx4 v[24:27], v3, s[36:39], s40 offen nt
    s_addk_i32 s40, 8192
    buffer_load_dwordx4 v[28:31], v3, s[36:39], s40 offen nt
    s_addk_i32 s40, 8192
    buffer_load_dwordx4 v[32:35], v3, s[36:39], s40 offen nt
    s_addk_i32 s40, 8192
    buffer_load_dwordx4 v[36:39], v3, s[36:39], s40 offen nt
    s_addk_i32 s40, 8192
    buffer_load_dwordx4 v[40:43], v3, s[36:39], s40 offen nt
    s_addk_i32 s40, 8192
    buffer_load_dwordx4 v[44:47], v3, s[36:39], s40 offen nt
    s_addk_i32 s40, 8192
    buffer_load_dwordx4 v[48:51], v3, s[36:39], s40 offen nt
    s_addk_i32 s40, 8192
    buffer_load_dwordx4 v[52:55], v3, s[36:39], s40 offen nt
    s_addk_i32 s40, 8192
    buffer_load_dwordx4 v[56:59], v3, s[36:39], s40 offen nt
    s_addk_i32 s40, 8192
    buffer_load_dwordx4 v[60:63], v3, s[36:39], s40 offen nt
    s_addk_i32 s40, 8192
    buffer_load_dwordx4 v[64:67], v3, s[36:39], s40 offen nt
    s_addk_i32 s40, 8192
    buffer_load_dwordx4 v[68:71], v3, s[36:39], s40 offen nt
    s_addk_i32 s40, 8192
    buffer_load_dwordx4 v[72:75], v3, s[36:39], s40 offen nt
    s_addk_i32 s40, 8192
    buffer_load_dwordx4 v[76:79], v3, s[36:39], s40 offen nt
    s_addk_i32 s40, 8192
    buffer_load_dwordx4 v[80:83], v3, s[36:39], s40 offen nt
    s_addk_i32 s40, 8192
    buffer_load_dwordx4 v[84:87], v3, s[36:39], s40 offen nt
    s_addk_i32 s40, 8192
    buffer_load_dwordx4 v[88:91], v3, s[36:39], s40 offen nt
    s_addk_i32 s40, 8192
    buffer_load_dwordx4 v[92:95], v3, s[36:39], s40 offen nt
    s_branch L_sec_v_7
L_sec_mt_8:
    v_and_b32 v50, 1, v0
    v_lshlrev_b32 v50, 4, v50
    v_mov_b32 v51, 0xffff
    v_lshlrev_b32 v51, v50, v51
    v_bfe_u32 v50, v0, 1, 2
    v_cmp_eq_u32 vcc, 0, v50
    s_nop 1
    v_cndmask_b32 v76, 0, v51, vcc
    v_cmp_eq_u32 vcc, 1, v50
    s_nop 1
    v_cndmask_b32 v77, 0, v51, vcc
    v_cmp_eq_u32 vcc, 2, v50
    s_nop 1
    v_cndmask_b32 v78, 0, v51, vcc
    v_cmp_eq_u32 vcc, 3, v50
    s_nop 1
    v_cndmask_b32 v79, 0, v51, vcc
    s_lshl_b32 s62, s43, 6
    s_lshl_b32 s2, s42, 2
    s_add_u32 s62, s62, s2
    s_add_u32 s62, s62, 40960
    v_mul_u32_u24 v58, 40, v58
    v_and_b32 v55, 1, v2
    v_lshlrev_b32 v55, 4, v55
    v_lshl_add_u32 v55, v59, 5, v55
    v_lshrrev_b32 v56, 1, v2
    v_lshl_add_u32 v55, v56, 3, v55
    s_mov_b32 s36, -1
    s_mov_b32 s37, 0
    s_waitcnt vmcnt(11)
    v_lshlrev_b32 v48, 16, v48
    v_mul_f32 v50, 0xbfb8aa3b, v48
    v_exp_f32 v50, v50
    s_nop 0
    v_add_f32 v50, 1.0, v50
    v_rcp_f32 v51, v50
    s_nop 0
    v_mul_f32 v52, v48, v51
    v_fma_f32 v53, -v52, v50, v48
    v_fma_f32 v53, v53, v51, v52
    v_div_fixup_f32 v48, v53, v50, v48
    v_cvt_pk_bf16_f32 v48, v48, v48
    ds_write_b32 v57, v48 offset:384
    v_lshlrev_b32 v49, 16, v49
    v_mul_f32 v50, 0xbfb8aa3b, v49
    v_exp_f32 v50, v50
    s_nop 0
    v_add_f32 v50, 1.0, v50
    v_rcp_f32 v51, v50
    s_nop 0
    v_mul_f32 v52, v49, v51
    v_fma_f32 v53, -v52, v50, v49
    v_fma_f32 v53, v53, v51, v52
    v_div_fixup_f32 v49, v53, v50, v49
    v_cvt_pk_bf16_f32 v49, v49, v49
    s_mov_b64 exec, s[36:37]
    ds_write_b32 v57, v49 offset:640
    s_mov_b64 exec, -1
    ds_read_b64 v[64:65], v58 offset:384
    ds_read_b64 v[66:67], v58 offset:392
    ds_read_b64 v[68:69], v58 offset:400
    ds_read_b64 v[70:71], v58 offset:408
    ds_read_b64 v[72:73], v58 offset:416
    s_mov_b32 s36, 0x00ff00ff
    s_mov_b32 s37, 0x00ff00ff
    s_waitcnt lgkmcnt(0)
    s_add_u32 s61, s61, 2654435769
    v_mov_b32 v50, s61
    v_and_b32 v80, v64, v76
    v_and_b32 v81, v64, v77
    v_and_b32 v82, v64, v78
    v_and_b32 v83, v64, v79
    v_and_b32 v84, v65, v76
    v_and_b32 v85, v65, v77
    v_and_b32 v86, v65, v78
    v_and_b32 v87, v65, v79
    s_waitcnt vmcnt(10)
    v_mfma_f32_16x16x32_bf16 v[60:63], v[80:83], v[8:11], 0
    v_and_b32 v80, v66, v76
    v_and_b32 v81, v66, v77
    v_and_b32 v82, v66, v78
    v_and_b32 v83, v66, v79
    s_waitcnt vmcnt(9)
    v_mfma_f32_16x16x32_bf16 v[60:63], v[84:87], v[12:15], v[60:63]
    v_and_b32 v84, v67, v76
    v_and_b32 v85, v67, v77
    v_and_b32 v86, v67, v78
    v_and_b32 v87, v67, v79
    s_waitcnt vmcnt(8)
    v_mfma_f32_16x16x32_bf16 v[60:63], v[80:83], v[16:19], v[60:63]
    v_and_b32 v80, v68, v76
    v_and_b32 v81, v68, v77
    v_and_b32 v82, v68, v78
    v_and_b32 v83, v68, v79
    s_waitcnt vmcnt(7)
    v_mfma_f32_16x16x32_bf16 v[60:63], v[84:87], v[20:23], v[60:63]
    v_and_b32 v84, v69, v76
    v_and_b32 v85, v69, v77
    v_and_b32 v86, v69, v78
    v_and_b32 v87, v69, v79
    s_waitcnt vmcnt(6)
    v_mfma_f32_16x16x32_bf16 v[60:63], v[80:83], v[24:27], v[60:63]
    v_and_b32 v80, v70, v76
    v_and_b32 v81, v70, v77
    v_and_b32 v82, v70, v78
    v_and_b32 v83, v70, v79
    s_waitcnt vmcnt(5)
    v_mfma_f32_16x16x32_bf16 v[60:63], v[84:87], v[28:31], v[60:63]
    v_and_b32 v84, v71, v76
    v_and_b32 v85, v71, v77
    v_and_b32 v86, v71, v78
    v_and_b32 v87, v71, v79
    s_waitcnt vmcnt(4)
    v_mfma_f32_16x16x32_bf16 v[60:63], v[80:83], v[32:35], v[60:63]
    v_and_b32 v80, v72, v76
    v_and_b32 v81, v72, v77
    v_and_b32 v82, v72, v78
    v_and_b32 v83, v72, v79
    s_waitcnt vmcnt(3)
    v_mfma_f32_16x16x32_bf16 v[60:63], v[84:87], v[36:39], v[60:63]
    v_and_b32 v84, v73, v76
    v_and_b32 v85, v73, v77
    v_and_b32 v86, v73, v78
    v_and_b32 v87, v73, v79
    s_waitcnt vmcnt(2)
    v_mfma_f32_16x16x32_bf16 v[60:63], v[80:83], v[40:43], v[60:63]
    s_waitcnt vmcnt(1)
    v_mfma_f32_16x16x32_bf16 v[60:63], v[84:87], v[44:47], v[60:63]
    s_waitcnt vmcnt(0)
    s_nop 6
    v_permlane32_swap_b32 v60, v62
    v_permlane32_swap_b32 v61, v63
    s_nop 1
    v_add_f32_dpp v60, v62, v60 row_ror:8 row_mask:0xf bank_mask:0xf
    v_add_f32_dpp v61, v63, v61 row_ror:8 row_mask:0xf bank_mask:0xf
    s_mov_b64 exec, s[36:37]
    buffer_store_dwordx2 v[60:61], v55, s[44:47], s60 offen sc1
    s_mov_b64 exec, 1
    buffer_store_dword v50, v4, s[44:47], s62 offen sc1
    s_mov_b64 exec, -1
    s_setprio 0
    s_branch L_vwave2
L_sec_svc1b_18:
    v_lshlrev_b32 v52, 2, v50
    v_mul_u32_u24 v53, 5120, v2
    v_lshl_add_u32 v53, v1, 4, v53
    s_lshl_b32 s62, s35, 9
    s_add_u32 s62, s62, 0
    s_add_u32 s63, s62, 20480
    v_min_u32 v54, 7, v1
    v_lshlrev_b32 v54, 2, v54
    v_and_b32 v55, 1, v2
    v_lshl_add_u32 v54, v55, 6, v54
    v_lshrrev_b32 v55, 1, v2
    v_mul_u32_u24 v55, 640, v55
    v_add_u32 v54, v54, v55
    s_lshl_b32 s65, s35, 7
    s_add_u32 s65, s65, 40960
    s_waitcnt vmcnt(0)
    v_lshlrev_b32 v64, 16, v56
    v_and_b32 v65, 0xffff0000, v56
    v_lshlrev_b32 v66, 16, v57
    v_and_b32 v67, 0xffff0000, v57
    v_lshlrev_b32 v68, 16, v58
    v_and_b32 v69, 0xffff0000, v58
    v_lshlrev_b32 v70, 16, v59
    v_and_b32 v71, 0xffff0000, v59
    v_lshlrev_b32 v72, 16, v60
    v_and_b32 v73, 0xffff0000, v60
    v_add_f32 v56, v64, v65
    v_add_f32 v56, v56, v66
    v_add_f32 v56, v56, v67
    v_add_f32 v56, v56, v68
    v_add_f32 v56, v56, v69
    v_add_f32 v56, v56, v70
    v_add_f32 v56, v56, v71
    v_add_f32 v56, v56, v72
    v_add_f32 v56, v56, v73
    s_nop 1
    v_add_f32_dpp v56, v56, v56 row_ror:8 row_mask:0xf bank_mask:0xf
    s_nop 1
    v_add_f32_dpp v56, v56, v56 row_ror:4 row_mask:0xf bank_mask:0xf
    s_nop 1
    v_add_f32_dpp v56, v56, v56 row_ror:2 row_mask:0xf bank_mask:0xf
    s_nop 1
    v_add_f32_dpp v56, v56, v56 row_ror:1 row_mask:0xf bank_mask:0xf
    s_nop 1
    v_add_f32_dpp v56, v56, v56 row_bcast:15 row_mask:0xa bank_mask:0xf
    s_nop 1
    v_add_f32_dpp v56, v56, v56 row_bcast:31 row_mask:0xc bank_mask:0xf
    s_nop 0
    v_readlane_b32 s2, v56, 63
    v_mov_b32 v57, 0x3acccccd
    s_nop 0
    v_mul_f32 v57, s2, v57
    v_sub_f32 v64, v64, v57
    v_sub_f32 v65, v65, v57
    v_sub_f32 v66, v66, v57
    v_sub_f32 v67, v67, v57
    v_sub_f32 v68, v68, v57
    v_sub_f32 v69, v69, v57
    v_sub_f32 v70, v70, v57
    v_sub_f32 v71, v71, v57
    v_sub_f32 v72, v72, v57
    v_sub_f32 v73, v73, v57
    v_mul_f32 v56, v64, v64
    v_fmac_f32 v56, v65, v65
    v_fmac_f32 v56, v66, v66
    v_fmac_f32 v56, v67, v67
    v_fmac_f32 v56, v68, v68
    v_fmac_f32 v56, v69, v69
    v_fmac_f32 v56, v70, v70
    v_fmac_f32 v56, v71, v71
    v_fmac_f32 v56, v72, v72
    v_fmac_f32 v56, v73, v73
    s_nop 1
    v_add_f32_dpp v56, v56, v56 row_ror:8 row_mask:0xf bank_mask:0xf
    s_nop 1
    v_add_f32_dpp v56, v56, v56 row_ror:4 row_mask:0xf bank_mask:0xf
    s_nop 1
    v_add_f32_dpp v56, v56, v56 row_ror:2 row_mask:0xf bank_mask:0xf
    s_nop 1
    v_add_f32_dpp v56, v56, v56 row_ror:1 row_mask:0xf bank_mask:0xf
    s_nop 1
    v_add_f32_dpp v56, v56, v56 row_bcast:15 row_mask:0xa bank_mask:0xf
    s_nop 1
    v_add_f32_dpp v56, v56, v56 row_bcast:31 row_mask:0xc bank_mask:0xf
    s_nop 0
    v_readlane_b32 s2, v56, 63
    v_mov_b32 v58, 0x3acccccd
    v_lshlrev_b32 v61, 16, v61
    v_lshlrev_b32 v62, 16, v62
    v_mul_f32 v58, s2, v58
    v_cvt_pk_bf16_f32 v57, v57, v57
    v_and_b32 v57, 0xffff0000, v57
    v_cvt_pk_bf16_f32 v58, v58, v58
    v_and_b32 v58, 0xffff0000, v58
    v_add_f32 v58, 0x3727c5ac, v58
    v_cvt_pk_bf16_f32 v58, v58, v58
    v_and_b32 v58, 0xffff0000, v58
    v_sqrt_f32 v58, v58
    s_nop 0
    v_cvt_pk_bf16_f32 v58, v58, v58
    v_and_b32 v58, 0xffff0000, v58
    v_rcp_f32 v59, v58
    s_nop 0
    v_sub_f32 v61, v61, v57
    v_sub_f32 v62, v62, v57
    v_cvt_pk_bf16_f32 v61, v61, v61
    v_and_b32 v61, 0xffff0000, v61
    v_cvt_pk_bf16_f32 v62, v62, v62
    v_and_b32 v62, 0xffff0000, v62
    v_mul_f32 v60, v61, v59
    v_mul_f32 v63, v62, v59
    v_fma_f32 v61, -v60, v58, v61
    v_fma_f32 v62, -v63, v58, v62
    v_fma_f32 v61, v61, v59, v60
    v_fma_f32 v62, v62, v59, v63
    v_cvt_pk_bf16_f32 v61, v61, v61
    v_and_b32 v61, 0xffff0000, v61
    v_cvt_pk_bf16_f32 v62, v62, v62
    v_and_b32 v62, 0xffff0000, v62
    s_waitcnt lgkmcnt(0)
    s_add_u32 s61, s61, 2654435769
    s_mov_b32 s3, 0
L_mp_19_t:
    buffer_load_dword v56, v54, s[44:47], s65 offen sc1
    s_add_u32 s3, s3, 1
    s_cmp_gt_u32 s3, 4194304
    s_cbranch_scc1 L_fin
    s_waitcnt vmcnt(0)
    v_cmp_ne_u32 vcc, s61, v56
    s_cbranch_vccz L_mp_19_tok
    s_sleep 2
    s_branch L_mp_19_t
L_mp_19_tok:
    s_mov_b32 s66, 0
L_mp_19:
    buffer_load_dwordx4 v[64:67], v53, s[44:47], s62 offen offset:0 sc1
    buffer_load_dwordx4 v[76:79], v53, s[44:47], s62 offen offset:256 sc1
    buffer_load_dwordx4 v[88:91], v53, s[44:47], s62 offen offset:2560 sc1
    buffer_load_dwordx4 v[100:103], v53, s[44:47], s62 offen offset:2816 sc1
    buffer_load_dwordx4 v[68:71], v53, s[44:47], s63 offen offset:0 sc1
    buffer_load_dwordx4 v[80:83], v53, s[44:47], s63 offen offset:256 sc1
    buffer_load_dwordx4 v[92:95], v53, s[44:47], s63 offen offset:2560 sc1
    buffer_load_dwordx4 v[104:107], v53, s[44:47], s63 offen offset:2816 sc1
    s_add_u32 s66, s66, 1
    s_cmp_gt_u32 s66, 524288
    s_waitcnt vmcnt(0)
    v_pk_add_f32 v[64:65], v[64:65], v[68:69]
    v_pk_add_f32 v[66:67], v[66:67], v[70:71]
    v_pk_add_f32 v[76:77], v[76:77], v[80:81]
    v_pk_add_f32 v[78:79], v[78:79], v[82:83]
    v_pk_add_f32 v[88:89], v[88:89], v[92:93]
    v_pk_add_f32 v[90:91], v[90:91], v[94:95]
    v_pk_add_f32 v[100:101], v[100:101], v[104:105]
    v_pk_add_f32 v[102:103], v[102:103], v[106:107]
    s_nop 1
    v_permlane32_swap_b32 v64, v66
    v_permlane32_swap_b32 v65, v67
    v_permlane32_swap_b32 v76, v78
    v_permlane32_swap_b32 v77, v79
    v_permlane32_swap_b32 v88, v90
    v_permlane32_swap_b32 v89, v91
    v_permlane32_swap_b32 v100, v102
    v_permlane32_swap_b32 v101, v103
    v_pk_add_f32 v[64:65], v[64:65], v[66:67]
    v_pk_add_f32 v[76:77], v[76:77], v[78:79]
    v_pk_add_f32 v[88:89], v[88:89], v[90:91]
    v_pk_add_f32 v[100:101], v[100:101], v[102:103]
    s_nop 1
    v_permlane16_swap_b32 v64, v65
    v_permlane16_swap_b32 v76, v77
    v_permlane16_swap_b32 v88, v89
    v_permlane16_swap_b32 v100, v101
    v_add_f32 v64, v64, v65
    v_add_f32 v76, v76, v77
    v_add_f32 v88, v88, v89
    v_add_f32 v100, v100, v101
    v_add_f32 v56, v64, v76
    v_add_f32 v57, v88, v100
    s_cbranch_scc1 L_mp_19_ok
    v_cmp_u_f32 vcc, v56, v57
    s_cbranch_vccnz L_mp_19
L_mp_19_ok:
    v_cvt_pk_bf16_f32 v64, v64, v88
    v_and_b32 v88, 0xffff0000, v64
    v_lshlrev_b32 v64, 16, v64
    v_add_f32 v88, 1.0, v88
    v_cvt_pk_bf16_f32 v88, v88, v88
    v_and_b32 v88, 0xffff0000, v88
    v_mul_f32 v88, v88, v61
    v_cvt_pk_bf16_f32 v88, v88, v88
    v_and_b32 v88, 0xffff0000, v88
    v_add_f32 v88, v88, v64
    v_cvt_pk_bf16_f32 v88, v88, v88
    ds_write_b32 v52, v88 offset:256
    v_cvt_pk_bf16_f32 v76, v76, v100
    v_and_b32 v100, 0xffff0000, v76
    v_lshlrev_b32 v76, 16, v76
    v_add_f32 v100, 1.0, v100
    v_cvt_pk_bf16_f32 v100, v100, v100
    v_and_b32 v100, 0xffff0000, v100
    v_mul_f32 v100, v100, v62
    v_cvt_pk_bf16_f32 v100, v100, v100
    v_and_b32 v100, 0xffff0000, v100
    v_add_f32 v100, v100, v76
    v_cvt_pk_bf16_f32 v100, v100, v100
    ds_write_b32 v52, v100 offset:512
    v_mov_b32 v56, 1
    s_mov_b64 exec, 1
    ds_add_u32 v15, v56 offset:24
    s_mov_b64 exec, -1
    s_branch L_fin
L_sec_svc1_13:
    s_mov_b32 s44, s30
    s_mov_b32 s45, s31
    s_mov_b32 s46, 270848
    s_mov_b32 s47, 0x20000
    v_and_b32 v72, 1, v0
    v_lshlrev_b32 v72, 4, v72
    v_mov_b32 v73, 0xffff
    v_lshlrev_b32 v73, v72, v73
    v_bfe_u32 v72, v0, 1, 2
    v_cmp_eq_u32 vcc, 0, v72
    s_nop 1
    v_cndmask_b32 v4, 0, v73, vcc
    v_cmp_eq_u32 vcc, 1, v72
    s_nop 1
    v_cndmask_b32 v5, 0, v73, vcc
    v_cmp_eq_u32 vcc, 2, v72
    s_nop 1
    v_cndmask_b32 v6, 0, v73, vcc
    v_cmp_eq_u32 vcc, 3, v72
    s_nop 1
    v_cndmask_b32 v7, 0, v73, vcc
    v_mov_b32 v72, 0
    v_lshl_add_u32 v73, v1, 2, v2
    s_lshl_b32 s2, s33, 8
    v_lshl_add_u32 v73, v73, 2, s2
    s_lshl_b32 s2, s33, 9
    v_lshlrev_b32 v74, 5, v1
    v_lshl_add_u32 v74, v2, 4, v74
    v_add_u32 v74, s2, v74
    v_and_b32 v75, 31, v0
    v_lshlrev_b32 v75, 4, v75
    v_lshrrev_b32 v76, 5, v0
    v_mul_u32_u24 v77, 2560, v76
    v_add_u32 v77, v77, v75
    v_lshrrev_b32 v75, 1, v75
    v_lshl_add_u32 v75, v76, 2, v75
    v_mov_b32 v76, 0xfffefffe
    v_mov_b32 v78, 1
    s_mov_b32 s36, -1
    s_mov_b32 s37, 0
    s_mov_b32 s3, 0
L_lw_14:
    ds_read_b32 v79, v72 offset:24
    s_add_u32 s3, s3, 1
    s_cmp_gt_u32 s3, 4194304
    s_cbranch_scc1 L_fin
    s_waitcnt lgkmcnt(0)
    v_readfirstlane_b32 s2, v79
    s_cmp_eq_u32 s2, 5
    s_cbranch_scc1 L_lw_14_ok
    s_sleep 1
    s_branch L_lw_14
L_lw_14_ok:
    ds_read_b32 v79, v73 offset:256
    s_waitcnt lgkmcnt(0)
    v_and_b32_dpp v80, v79, v4 row_newbcast:0 row_mask:0xf bank_mask:0xf
    v_and_b32_dpp v81, v79, v5 row_newbcast:0 row_mask:0xf bank_mask:0xf
    v_and_b32_dpp v82, v79, v6 row_newbcast:0 row_mask:0xf bank_mask:0xf
    v_and_b32_dpp v83, v79, v7 row_newbcast:0 row_mask:0xf bank_mask:0xf
    v_and_b32_dpp v84, v79, v4 row_newbcast:1 row_mask:0xf bank_mask:0xf
    v_and_b32_dpp v85, v79, v5 row_newbcast:1 row_mask:0xf bank_mask:0xf
    v_and_b32_dpp v86, v79, v6 row_newbcast:1 row_mask:0xf bank_mask:0xf
    v_and_b32_dpp v87, v79, v7 row_newbcast:1 row_mask:0xf bank_mask:0xf
    s_waitcnt vmcnt(15)
    v_mfma_f32_16x16x32_bf16 v[88:91], v[80:83], v[8:11], 0
    v_and_b32_dpp v80, v79, v4 row_newbcast:2 row_mask:0xf bank_mask:0xf
    v_and_b32_dpp v81, v79, v5 row_newbcast:2 row_mask:0xf bank_mask:0xf
    v_and_b32_dpp v82, v79, v6 row_newbcast:2 row_mask:0xf bank_mask:0xf
    v_and_b32_dpp v83, v79, v7 row_newbcast:2 row_mask:0xf bank_mask:0xf
    s_waitcnt vmcnt(14)
    v_mfma_f32_16x16x32_bf16 v[88:91], v[84:87], v[12:15], v[88:91]
    v_and_b32_dpp v84, v79, v4 row_newbcast:3 row_mask:0xf bank_mask:0xf
    v_and_b32_dpp v85, v79, v5 row_newbcast:3 row_mask:0xf bank_mask:0xf
    v_and_b32_dpp v86, v79, v6 row_newbcast:3 row_mask:0xf bank_mask:0xf
    v_and_b32_dpp v87, v79, v7 row_newbcast:3 row_mask:0xf bank_mask:0xf
    s_waitcnt vmcnt(13)
    v_mfma_f32_16x16x32_bf16 v[88:91], v[80:83], v[16:19], v[88:91]
    v_and_b32_dpp v80, v79, v4 row_newbcast:4 row_mask:0xf bank_mask:0xf
    v_and_b32_dpp v81, v79, v5 row_newbcast:4 row_mask:0xf bank_mask:0xf
    v_and_b32_dpp v82, v79, v6 row_newbcast:4 row_mask:0xf bank_mask:0xf
    v_and_b32_dpp v83, v79, v7 row_newbcast:4 row_mask:0xf bank_mask:0xf
    s_waitcnt vmcnt(12)
    v_mfma_f32_16x16x32_bf16 v[88:91], v[84:87], v[20:23], v[88:91]
    v_and_b32_dpp v84, v79, v4 row_newbcast:5 row_mask:0xf bank_mask:0xf
    v_and_b32_dpp v85, v79, v5 row_newbcast:5 row_mask:0xf bank_mask:0xf
    v_and_b32_dpp v86, v79, v6 row_newbcast:5 row_mask:0xf bank_mask:0xf
    v_and_b32_dpp v87, v79, v7 row_newbcast:5 row_mask:0xf bank_mask:0xf
    s_waitcnt vmcnt(11)
    v_mfma_f32_16x16x32_bf16 v[88:91], v[80:83], v[24:27], v[88:91]
    v_and_b32_dpp v80, v79, v4 row_newbcast:6 row_mask:0xf bank_mask:0xf
    v_and_b32_dpp v81, v79, v5 row_newbcast:6 row_mask:0xf bank_mask:0xf
    v_and_b32_dpp v82, v79, v6 row_newbcast:6 row_mask:0xf bank_mask:0xf
    v_and_b32_dpp v83, v79, v7 row_newbcast:6 row_mask:0xf bank_mask:0xf
    s_waitcnt vmcnt(10)
    v_mfma_f32_16x16x32_bf16 v[88:91], v[84:87], v[28:31], v[88:91]
    v_and_b32_dpp v84, v79, v4 row_newbcast:7 row_mask:0xf bank_mask:0xf
    v_and_b32_dpp v85, v79, v5 row_newbcast:7 row_mask:0xf bank_mask:0xf
    v_and_b32_dpp v86, v79, v6 row_newbcast:7 row_mask:0xf bank_mask:0xf
    v_and_b32_dpp v87, v79, v7 row_newbcast:7 row_mask:0xf bank_mask:0xf
    s_waitcnt vmcnt(9)
    v_mfma_f32_16x16x32_bf16 v[88:91], v[80:83], v[32:35], v[88:91]
    v_and_b32_dpp v80, v79, v4 row_newbcast:8 row_mask:0xf bank_mask:0xf
    v_and_b32_dpp v81, v79, v5 row_newbcast:8 row_mask:0xf bank_mask:0xf
    v_and_b32_dpp v82, v79, v6 row_newbcast:8 row_mask:0xf bank_mask:0xf
    v_and_b32_dpp v83, v79, v7 row_newbcast:8 row_mask:0xf bank_mask:0xf
    s_waitcnt vmcnt(8)
    v_mfma_f32_16x16x32_bf16 v[88:91], v[84:87], v[36:39], v[88:91]
    v_and_b32_dpp v84, v79, v4 row_newbcast:9 row_mask:0xf bank_mask:0xf
    v_and_b32_dpp v85, v79, v5 row_newbcast:9 row_mask:0xf bank_mask:0xf
    v_and_b32_dpp v86, v79, v6 row_newbcast:9 row_mask:0xf bank_mask:0xf
    v_and_b32_dpp v87, v79, v7 row_newbcast:9 row_mask:0xf bank_mask:0xf
    s_waitcnt vmcnt(7)
    v_mfma_f32_16x16x32_bf16 v[88:91], v[80:83], v[40:43], v[88:91]
    v_and_b32_dpp v80, v79, v4 row_newbcast:10 row_mask:0xf bank_mask:0xf
    v_and_b32_dpp v81, v79, v5 row_newbcast:10 row_mask:0xf bank_mask:0xf
    v_and_b32_dpp v82, v79, v6 row_newbcast:10 row_mask:0xf bank_mask:0xf
    v_and_b32_dpp v83, v79, v7 row_newbcast:10 row_mask:0xf bank_mask:0xf
    s_waitcnt vmcnt(6)
    v_mfma_f32_16x16x32_bf16 v[88:91], v[84:87], v[44:47], v[88:91]
    v_and_b32_dpp v84, v79, v4 row_newbcast:11 row_mask:0xf bank_mask:0xf
    v_and_b32_dpp v85, v79, v5 row_newbcast:11 row_mask:0xf bank_mask:0xf
    v_and_b32_dpp v86, v79, v6 row_newbcast:11 row_mask:0xf bank_mask:0xf
    v_and_b32_dpp v87, v79, v7 row_newbcast:11 row_mask:0xf bank_mask:0xf
    s_waitcnt vmcnt(5)
    v_mfma_f32_16x16x32_bf16 v[88:91], v[80:83], v[48:51], v[88:91]
    v_and_b32_dpp v80, v79, v4 row_newbcast:12 row_mask:0xf bank_mask:0xf
    v_and_b32_dpp v81, v79, v5 row_newbcast:12 row_mask:0xf bank_mask:0xf
    v_and_b32_dpp v82, v79, v6 row_newbcast:12 row_mask:0xf bank_mask:0xf
    v_and_b32_dpp v83, v79, v7 row_newbcast:12 row_mask:0xf bank_mask:0xf
    s_waitcnt vmcnt(4)
    v_mfma_f32_16x16x32_bf16 v[88:91], v[84:87], v[52:55], v[88:91]
    v_and_b32_dpp v84, v79, v4 row_newbcast:13 row_mask:0xf bank_mask:0xf
    v_and_b32_dpp v85, v79, v5 row_newbcast:13 row_mask:0xf bank_mask:0xf
    v_and_b32_dpp v86, v79, v6 row_newbcast:13 row_mask:0xf bank_mask:0xf
    v_and_b32_dpp v87, v79, v7 row_newbcast:13 row_mask:0xf bank_mask:0xf
    s_waitcnt vmcnt(3)
    v_mfma_f32_16x16x32_bf16 v[88:91], v[80:83], v[56:59], v[88:91]
    v_and_b32_dpp v80, v79, v4 row_newbcast:14 row_mask:0xf bank_mask:0xf
    v_and_b32_dpp v81, v79, v5 row_newbcast:14 row_mask:0xf bank_mask:0xf
    v_and_b32_dpp v82, v79, v6 row_newbcast:14 row_mask:0xf bank_mask:0xf
    v_and_b32_dpp v83, v79, v7 row_newbcast:14 row_mask:0xf bank_mask:0xf
    s_waitcnt vmcnt(2)
    v_mfma_f32_16x16x32_bf16 v[88:91], v[84:87], v[60:63], v[88:91]
    v_and_b32_dpp v84, v79, v4 row_newbcast:15 row_mask:0xf bank_mask:0xf
    v_and_b32_dpp v85, v79, v5 row_newbcast:15 row_mask:0xf bank_mask:0xf
    v_and_b32_dpp v86, v79, v6 row_newbcast:15 row_mask:0xf bank_mask:0xf
    v_and_b32_dpp v87, v79, v7 row_newbcast:15 row_mask:0xf bank_mask:0xf
    s_waitcnt vmcnt(1)
    v_mfma_f32_16x16x32_bf16 v[88:91], v[80:83], v[64:67], v[88:91]
    s_waitcnt vmcnt(0)
    v_mfma_f32_16x16x32_bf16 v[88:91], v[84:87], v[68:71], v[88:91]
    s_mov_b64 exec, s[36:37]
    s_nop 6
    ds_write_b128 v74, v[88:91] offset:2816
    s_mov_b64 exec, 1
    ds_add_rtn_u32 v78, v72, v78 offset:28
    s_mov_b64 exec, -1
    s_waitcnt lgkmcnt(0)
    v_readfirstlane_b32 s2, v78
    s_cmp_eq_u32 s2, 9
    s_cbranch_scc0 L_qdone
    s_setprio 3
    ds_read_b128 v[8:11], v77 offset:2816
    ds_read_b128 v[12:15], v77 offset:3328
    ds_read_b128 v[16:19], v77 offset:3840
    ds_read_b128 v[20:23], v77 offset:4352
    ds_read_b128 v[24:27], v77 offset:4864
    s_waitcnt lgkmcnt(3)
    v_pk_add_f32 v[8:9], v[8:9], v[12:13]
    v_pk_add_f32 v[10:11], v[10:11], v[14:15]
    s_waitcnt lgkmcnt(2)
    v_pk_add_f32 v[8:9], v[8:9], v[16:17]
    v_pk_add_f32 v[10:11], v[10:11], v[18:19]
    s_waitcnt lgkmcnt(1)
    v_pk_add_f32 v[8:9], v[8:9], v[20:21]
    v_pk_add_f32 v[10:11], v[10:11], v[22:23]
    s_waitcnt lgkmcnt(0)
    v_pk_add_f32 v[8:9], v[8:9], v[24:25]
    v_pk_add_f32 v[10:11], v[10:11], v[26:27]
    s_nop 1
    v_permlane32_swap_b32 v8, v10
    v_permlane32_swap_b32 v9, v11
    v_pk_add_f32 v[8:9], v[8:9], v[10:11]
    v_cvt_pk_bf16_f32 v12, v8, v9
    v_pk_min_u16 v12, v12, v76
    s_mov_b32 s3, 0
L_lw_15:
    ds_read_b32 v13, v72 offset:0
    s_add_u32 s3, s3, 1
    s_cmp_gt_u32 s3, 4194304
    s_cbranch_scc1 L_fin
    s_waitcnt lgkmcnt(0)
    v_readfirstlane_b32 s2, v13
    s_cmp_eq_u32 s2, 1
    s_cbranch_scc0 L_lw_15
    buffer_store_dword v12, v75, s[44:47], s41 offen sc1
    v_mov_b32 v78, 1
    s_mov_b64 exec, 1
    ds_write_b32 v72, v78 offset:20
    s_mov_b64 exec, -1
    s_setprio 0
L_qdone:
    s_cmp_ge_u32 s34, 10
    s_cbranch_scc1 L_fin
    s_mov_b32 s3, 0
L_lw_16:
    ds_read_b32 v13, v72 offset:4
    s_add_u32 s3, s3, 1
    s_cmp_gt_u32 s3, 4194304
    s_cbranch_scc1 L_fin
    s_waitcnt lgkmcnt(0)
    v_readfirstlane_b32 s2, v13
    s_cmp_eq_u32 s2, 1
    s_cbranch_scc1 L_lw_16_ok
    s_sleep 4
    s_branch L_lw_16
L_lw_16_ok:
    s_add_u32 s60, s34, 30
    s_mov_b32 s34, 32
L_mblk0:
    v_lshrrev_b32 v8, 3, v0
    v_and_b32 v9, 7, v0
    v_lshlrev_b32 v14, 2, v0
    v_mov_b32 v15, 0
    s_lshl_b32 s2, s33, 7
    v_lshl_add_u32 v11, v0, 1, s2
    s_lshl_b32 s2, s33, 6
    v_lshl_add_u32 v10, v8, 3, s2
    s_movk_i32 s2, 7680
    v_mul_lo_u32 v12, v10, s2
    v_lshl_add_u32 v12, v9, 4, v12
    s_mov_b32 s36, s24
    s_mov_b32 s37, s25
    s_mov_b32 s38, 4915200
    s_mov_b32 s52, s22
    s_mov_b32 s53, s23
    s_mov_b32 s54, 1280
    s_mov_b32 s55, 0x20000
    buffer_load_ushort v16, v11, s[52:55], 0 offen
    v_bfe_u32 v13, v0, 3, 1
    s_lshl_b32 s2, s33, 1
    v_add_u32 v13, s2, v13
    v_lshlrev_b32 v13, 8, v13
    v_lshl_add_u32 v13, v9, 5, v13
    v_and_b32 v10, 1, v2
    v_lshl_add_u32 v13, v10, 4, v13
    s_lshl_b32 s2, s33, 8
    v_add_u32 v10, s2, v14
    v_lshl_add_u32 v11, v8, 5, s2
    v_mov_b32 v21, 0
    s_waitcnt vmcnt(0)
    v_lshlrev_b32 v16, 16, v16
    v_mul_f32 v17, 0xbfb8aa3b, v16
    v_exp_f32 v17, v17
    s_nop 0
    v_add_f32 v17, 1.0, v17
    v_rcp_f32 v18, v17
    s_nop 0
    v_mul_f32 v19, v16, v18
    v_fma_f32 v20, -v19, v17, v16
    v_fma_f32 v20, v20, v18, v19
    v_div_fixup_f32 v16, v20, v17, v16
    v_cvt_pk_bf16_f32 v16, v16, v16
    ds_write_b32 v10, v16 offset:7936
    ds_read_b128 v[24:27], v11 offset:7936
    ds_read_b128 v[28:31], v11 offset:7952
    v_lshlrev_b32 v11, 1, v0
L_mblk:
    s_lshl_b32 s40, s60, 7
    s_add_u32 s42, s40, 53248
    s_addk_i32 s40, 2560
    buffer_load_dwordx4 v[40:43], v12, s[36:39], s40 offen nt
    s_addk_i32 s40, 7680
    buffer_load_dwordx4 v[44:47], v12, s[36:39], s40 offen nt
    s_addk_i32 s40, 7680
    buffer_load_dwordx4 v[48:51], v12, s[36:39], s40 offen nt
    s_addk_i32 s40, 7680
    buffer_load_dwordx4 v[52:55], v12, s[36:39], s40 offen nt
    s_addk_i32 s40, 7680
    buffer_load_dwordx4 v[56:59], v12, s[36:39], s40 offen nt
    s_addk_i32 s40, 7680
    buffer_load_dwordx4 v[60:63], v12, s[36:39], s40 offen nt
    s_addk_i32 s40, 7680
    buffer_load_dwordx4 v[64:67], v12, s[36:39], s40 offen nt
    s_addk_i32 s40, 7680
    buffer_load_dwordx4 v[68:71], v12, s[36:39], s40 offen nt
    s_mov_b32 s56, 0x00ff00ff
    s_mov_b32 s57, 0xff00ff00
    v_mov_b32 v20, 1
    s_waitcnt lgkmcnt(0)
    v_and_b32 v32, v24, v4
    v_and_b32 v33, v24, v5
    v_and_b32 v34, v24, v6
    v_and_b32 v35, v24, v7
    v_and_b32 v36, v25, v4
    v_and_b32 v37, v25, v5
    v_and_b32 v38, v25, v6
    v_and_b32 v39, v25, v7
    s_waitcnt vmcnt(7)
    v_mfma_f32_16x16x32_bf16 v[16:19], v[32:35], v[40:43], 0
    v_and_b32 v32, v26, v4
    v_and_b32 v33, v26, v5
    v_and_b32 v34, v26, v6
    v_and_b32 v35, v26, v7
    s_waitcnt vmcnt(6)
    v_mfma_f32_16x16x32_bf16 v[16:19], v[36:39], v[44:47], v[16:19]
    v_and_b32 v36, v27, v4
    v_and_b32 v37, v27, v5
    v_and_b32 v38, v27, v6
    v_and_b32 v39, v27, v7
    s_waitcnt vmcnt(5)
    v_mfma_f32_16x16x32_bf16 v[16:19], v[32:35], v[48:51], v[16:19]
    v_and_b32 v32, v28, v4
    v_and_b32 v33, v28, v5
    v_and_b32 v34, v28, v6
    v_and_b32 v35, v28, v7
    s_waitcnt vmcnt(4)
    v_mfma_f32_16x16x32_bf16 v[16:19], v[36:39], v[52:55], v[16:19]
    v_and_b32 v36, v29, v4
    v_and_b32 v37, v29, v5
    v_and_b32 v38, v29, v6
    v_and_b32 v39, v29, v7
    s_waitcnt vmcnt(3)
    v_mfma_f32_16x16x32_bf16 v[16:19], v[32:35], v[56:59], v[16:19]
    v_and_b32 v32, v30, v4
    v_and_b32 v33, v30, v5
    v_and_b32 v34, v30, v6
    v_and_b32 v35, v30, v7
    s_waitcnt vmcnt(2)
    v_mfma_f32_16x16x32_bf16 v[16:19], v[36:39], v[60:63], v[16:19]
    v_and_b32 v36, v31, v4
    v_and_b32 v37, v31, v5
    v_and_b32 v38, v31, v6
    v_and_b32 v39, v31, v7
    s_waitcnt vmcnt(1)
    v_mfma_f32_16x16x32_bf16 v[16:19], v[32:35], v[64:67], v[16:19]
    s_waitcnt vmcnt(0)
    v_mfma_f32_16x16x32_bf16 v[16:19], v[36:39], v[68:71], v[16:19]
    s_mov_b64 exec, s[56:57]
    s_nop 6
    ds_write_b128 v13, v[16:19] offset:20736
    s_mov_b64 exec, 1
    ds_add_rtn_u32 v20, v21, v20 offset:36
    s_mov_b64 exec, -1
    s_waitcnt lgkmcnt(0)
    v_readfirstlane_b32 s2, v20
    s_cmp_eq_u32 s2, 9
    s_cbranch_scc0 L_mnext
    ds_read2st64_b32 v[40:41], v14 offset0:81 offset1:82
    ds_read2st64_b32 v[42:43], v14 offset0:83 offset1:84
    ds_read2st64_b32 v[44:45], v14 offset0:85 offset1:86
    ds_read2st64_b32 v[46:47], v14 offset0:87 offset1:88
    ds_read2st64_b32 v[48:49], v14 offset0:89 offset1:90
    ds_read2st64_b32 v[50:51], v14 offset0:91 offset1:92
    ds_read2st64_b32 v[52:53], v14 offset0:93 offset1:94
    ds_read2st64_b32 v[54:55], v14 offset0:95 offset1:96
    ds_read2st64_b32 v[56:57], v14 offset0:97 offset1:98
    ds_read2st64_b32 v[58:59], v14 offset0:99 offset1:100
    s_waitcnt lgkmcnt(8)
    v_pk_add_f32 v[40:41], v[40:41], v[42:43]
    s_waitcnt lgkmcnt(7)
    v_pk_add_f32 v[40:41], v[40:41], v[44:45]
    s_waitcnt lgkmcnt(6)
    v_pk_add_f32 v[40:41], v[40:41], v[46:47]
    s_waitcnt lgkmcnt(5)
    v_pk_add_f32 v[40:41], v[40:41], v[48:49]
    s_waitcnt lgkmcnt(4)
    v_pk_add_f32 v[40:41], v[40:41], v[50:51]
    s_waitcnt lgkmcnt(3)
    v_pk_add_f32 v[40:41], v[40:41], v[52:53]
    s_waitcnt lgkmcnt(2)
    v_pk_add_f32 v[40:41], v[40:41], v[54:55]
    s_waitcnt lgkmcnt(1)
    v_pk_add_f32 v[40:41], v[40:41], v[56:57]
    s_waitcnt lgkmcnt(0)
    v_pk_add_f32 v[40:41], v[40:41], v[58:59]
    v_add_f32 v40, v40, v41
    v_cvt_pk_bf16_f32 v40, v40, v40
    v_and_b32 v40, 0xffff, v40
    v_min_u32 v40, 0xfffe, v40
    s_mov_b32 s3, 0
L_lw_17:
    ds_read_b32 v20, v15 offset:0
    s_add_u32 s3, s3, 1
    s_cmp_gt_u32 s3, 4194304
    s_cbranch_scc1 L_fin
    s_waitcnt lgkmcnt(0)
    v_readfirstlane_b32 s2, v20
    s_cmp_eq_u32 s2, 1
    s_cbranch_scc1 L_lw_17_ok
    s_sleep 1
    s_branch L_lw_17
L_lw_17_ok:
    buffer_store_short v40, v11, s[44:47], s42 offen sc1
    v_mov_b32 v20, 1
    s_mov_b64 exec, 1
    ds_write_b32 v15, v20 offset:32
    s_mov_b64 exec, -1
L_mnext:
    s_cmp_lt_u32 s34, 27
    s_cbranch_scc1 L_gwave
    s_branch L_fin
L_gwave:
    s_lshl_b32 s2, s35, 6
    v_lshl_add_u32 v10, v8, 3, s2
    s_movk_i32 s2, 3456
    v_mul_lo_u32 v12, v10, s2
    v_lshl_add_u32 v12, v9, 4, v12
    s_lshl_b32 s40, s34, 7
    s_waitcnt lgkmcnt(0)
    s_load_dword s61, s[30:31], 44032
    s_mov_b32 s36, s16
    s_mov_b32 s37, s17
    s_mov_b32 s38, 2211840
    s_mov_b32 s48, s18
    s_mov_b32 s49, s19
    s_mov_b32 s50, 2211840
    s_mov_b32 s51, 0x20000
    s_mov_b32 s52, s4
    s_mov_b32 s53, s5
    s_mov_b32 s54, 1280
    s_mov_b32 s55, 0x20000
    s_lshl_b32 s2, s35, 7
    v_lshl_add_u32 v21, v1, 2, v2
    v_lshl_add_u32 v20, v21, 1, s2
    s_mov_b32 s3, 0
L_lw_20:
    ds_read_b32 v24, v15 offset:32
    s_add_u32 s3, s3, 1
    s_cmp_gt_u32 s3, 4194304
    s_cbranch_scc1 L_fin
    s_waitcnt lgkmcnt(0)
    v_readfirstlane_b32 s2, v24
    s_cmp_eq_u32 s2, 1
    s_cbranch_scc1 L_lw_20_ok
    s_sleep 1
    s_branch L_lw_20
L_lw_20_ok:
    buffer_load_ushort v24, v20, s[52:55], 0 offen
    buffer_load_dwordx4 v[56:59], v12, s[36:39], s40 offen nt
    buffer_load_dwordx4 v[88:91], v12, s[48:51], s40 offen nt
    s_addk_i32 s40, 3456
    buffer_load_dwordx4 v[60:63], v12, s[36:39], s40 offen nt
    buffer_load_dwordx4 v[92:95], v12, s[48:51], s40 offen nt
    s_addk_i32 s40, 3456
    buffer_load_dwordx4 v[64:67], v12, s[36:39], s40 offen nt
    buffer_load_dwordx4 v[96:99], v12, s[48:51], s40 offen nt
    s_addk_i32 s40, 3456
    buffer_load_dwordx4 v[68:71], v12, s[36:39], s40 offen nt
    buffer_load_dwordx4 v[100:103], v12, s[48:51], s40 offen nt
    s_addk_i32 s40, 3456
    buffer_load_dwordx4 v[72:75], v12, s[36:39], s40 offen nt
    buffer_load_dwordx4 v[104:107], v12, s[48:51], s40 offen nt
    s_addk_i32 s40, 3456
    buffer_load_dwordx4 v[76:79], v12, s[36:39], s40 offen nt
    buffer_load_dwordx4 v[108:111], v12, s[48:51], s40 offen nt
    s_addk_i32 s40, 3456
    buffer_load_dwordx4 v[80:83], v12, s[36:39], s40 offen nt
    buffer_load_dwordx4 v[112:115], v12, s[48:51], s40 offen nt
    s_addk_i32 s40, 3456
    buffer_load_dwordx4 v[84:87], v12, s[36:39], s40 offen nt
    buffer_load_dwordx4 v[116:119], v12, s[48:51], s40 offen nt
    s_branch L_sec_svc2_21
L_dwave:
    s_cmp_ge_u32 s34, 27
    s_cbranch_scc1 L_fin
    s_sub_u32 s35, s33, 10
    v_mul_u32_u24 v10, 20480, v2
    v_lshl_add_u32 v10, v1, 4, v10
    s_mul_i32 s40, s34, 81920
    s_lshl_b32 s2, s35, 8
    s_add_u32 s40, s40, s2
    s_mov_b32 s38, 2211840
    s_mov_b32 s39, 0x20000
    s_waitcnt lgkmcnt(0)
    s_mov_b32 s36, s20
    s_mov_b32 s37, s21
    v_mov_b32 v15, 0
    v_lshlrev_b32 v14, 2, v0
    s_barrier
    s_setprio 3
    buffer_load_dwordx4 v[56:59], v10, s[36:39], s40 offen offset:0 nt
    buffer_load_dwordx4 v[60:63], v10, s[36:39], s40 offen offset:1280 nt
    buffer_load_dwordx4 v[64:67], v10, s[36:39], s40 offen offset:2560 nt
    s_addk_i32 s40, 3840
    buffer_load_dwordx4 v[68:71], v10, s[36:39], s40 offen offset:0 nt
    buffer_load_dwordx4 v[72:75], v10, s[36:39], s40 offen offset:1280 nt
    buffer_load_dwordx4 v[76:79], v10, s[36:39], s40 offen offset:2560 nt
    s_addk_i32 s40, 3840
    buffer_load_dwordx4 v[80:83], v10, s[36:39], s40 offen offset:0 nt
    buffer_load_dwordx4 v[84:87], v10, s[36:39], s40 offen offset:1280 nt
    buffer_load_dwordx4 v[88:91], v10, s[36:39], s40 offen offset:2560 nt
    s_addk_i32 s40, 3840
    buffer_load_dwordx4 v[92:95], v10, s[36:39], s40 offen offset:0 nt
    buffer_load_dwordx4 v[96:99], v10, s[36:39], s40 offen offset:1280 nt
    buffer_load_dwordx4 v[100:103], v10, s[36:39], s40 offen offset:2560 nt
    s_addk_i32 s40, 3840
    buffer_load_dwordx4 v[104:107], v10, s[36:39], s40 offen offset:0 nt
    buffer_load_dwordx4 v[108:111], v10, s[36:39], s40 offen offset:1280 nt
    buffer_load_dwordx4 v[112:115], v10, s[36:39], s40 offen offset:2560 nt
    s_addk_i32 s40, 3840
    buffer_load_dwordx4 v[116:119], v10, s[36:39], s40 offen offset:0 nt
    v_mov_b32 v24, 1
    s_mov_b64 exec, 1
    ds_add_u32 v15, v24 offset:24
    s_mov_b64 exec, -1
    s_branch L_sec_svc2_27
L_kiss_done:
    s_mov_b32 s44, s30
    s_mov_b32 s45, s31
    s_mov_b32 s46, 270848
    s_mov_b32 s47, 0x20000
    s_cmp_eq_u32 s33, 0
    s_cbranch_scc1 L_qwave
L_kcomp:
    v_mov_b32 v4, 0
    v_and_b32 v104, 3, v1
    v_bfe_u32 v105, v1, 2, 1
    v_bfe_u32 v106, v1, 3, 1
    v_lshl_or_b32 v105, v105, 1, v106
    v_lshl_add_u32 v104, v104, 2, v105
    v_lshl_add_u32 v104, v104, 2, v2
    s_mul_i32 s2, s33, 384
    v_lshl_add_u32 v104, v104, 2, s2
    s_mov_b32 s52, 0x22222222
    s_mov_b32 s53, 0x22222222
    v_add_u32 v106, 4, v106
    v_cndmask_b32 v105, v105, v106, s[52:53]
    v_lshl_add_u32 v105, v105, 2, v2
    v_lshl_add_u32 v105, v105, 2, s2
    v_lshlrev_b32 v5, 4, v1
    s_mov_b32 s54, 0x44444444
    s_mov_b32 s55, 0x44444444
    s_mov_b32 s56, 0x88888888
    s_mov_b32 s57, 0x88888888
    s_mov_b32 s60, 0x13131313
    s_mov_b32 s61, s60
    s_add_u32 s2, s33, 168
    s_cmp_lt_u32 s2, s32
    s_cselect_b32 s58, s60, 0x11131113
    s_mov_b32 s59, s58
    s_mov_b32 s62, 1035273459
    s_mov_b32 s63, 1069066811
    s_lshl_b32 s2, s33, 3
    v_mov_b32 v107, s2
    s_mov_b32 s3, 0
L_lw_2:
    ds_read_b32 v6, v4 offset:0
    s_add_u32 s3, s3, 1
    s_cmp_gt_u32 s3, 4194304
    s_cbranch_scc1 L_fin
    s_waitcnt lgkmcnt(0)
    v_readfirstlane_b32 s2, v6
    s_cmp_eq_u32 s2, 1
    s_cbranch_scc1 L_lw_2_ok
    s_sleep 1
    s_branch L_lw_2
L_lw_2_ok:
    ds_read_b128 v[96:99], v5 offset:128
    s_waitcnt vmcnt(0) lgkmcnt(0)
    v_dot2_f32_bf16 v8, v8, v96, 0
    v_dot2_f32_bf16 v12, v12, v96, 0
    v_dot2_f32_bf16 v16, v16, v96, 0
    v_dot2_f32_bf16 v20, v20, v96, 0
    v_dot2_f32_bf16 v24, v24, v96, 0
    v_dot2_f32_bf16 v28, v28, v96, 0
    v_dot2_f32_bf16 v32, v32, v96, 0
    v_dot2_f32_bf16 v36, v36, v96, 0
    v_dot2_f32_bf16 v40, v40, v96, 0
    v_dot2_f32_bf16 v44, v44, v96, 0
    v_dot2_f32_bf16 v48, v48, v96, 0
    v_dot2_f32_bf16 v52, v52, v96, 0
    v_dot2_f32_bf16 v56, v56, v96, 0
    v_dot2_f32_bf16 v60, v60, v96, 0
    v_dot2_f32_bf16 v64, v64, v96, 0
    v_dot2_f32_bf16 v68, v68, v96, 0
    v_dot2_f32_bf16 v72, v72, v96, 0
    v_dot2_f32_bf16 v76, v76, v96, 0
    v_dot2_f32_bf16 v80, v80, v96, 0
    v_dot2_f32_bf16 v84, v84, v96, 0
    v_dot2_f32_bf16 v88, v88, v96, 0
    v_dot2_f32_bf16 v92, v92, v96, 0
    v_dot2c_f32_bf16 v8, v9, v97
    v_dot2c_f32_bf16 v12, v13, v97
    v_dot2c_f32_bf16 v16, v17, v97
    v_dot2c_f32_bf16 v20, v21, v97
    v_dot2c_f32_bf16 v24, v25, v97
    v_dot2c_f32_bf16 v28, v29, v97
    v_dot2c_f32_bf16 v32, v33, v97
    v_dot2c_f32_bf16 v36, v37, v97
    v_dot2c_f32_bf16 v40, v41, v97
    v_dot2c_f32_bf16 v44, v45, v97
    v_dot2c_f32_bf16 v48, v49, v97
    v_dot2c_f32_bf16 v52, v53, v97
    v_dot2c_f32_bf16 v56, v57, v97
    v_dot2c_f32_bf16 v60, v61, v97
    v_dot2c_f32_bf16 v64, v65, v97
    v_dot2c_f32_bf16 v68, v69, v97
    v_dot2c_f32_bf16 v72, v73, v97
    v_dot2c_f32_bf16 v76, v77, v97
    v_dot2c_f32_bf16 v80, v81, v97
    v_dot2c_f32_bf16 v84, v85, v97
    v_dot2c_f32_bf16 v88, v89, v97
    v_dot2c_f32_bf16 v92, v93, v97
    v_dot2c_f32_bf16 v8, v10, v98
    v_dot2c_f32_bf16 v12, v14, v98
    v_dot2c_f32_bf16 v16, v18, v98
    v_dot2c_f32_bf16 v20, v22, v98
    v_dot2c_f32_bf16 v24, v26, v98
    v_dot2c_f32_bf16 v28, v30, v98
    v_dot2c_f32_bf16 v32, v34, v98
    v_dot2c_f32_bf16 v36, v38, v98
    v_dot2c_f32_bf16 v40, v42, v98
    v_dot2c_f32_bf16 v44, v46, v98
    v_dot2c_f32_bf16 v48, v50, v98
    v_dot2c_f32_bf16 v52, v54, v98
    v_dot2c_f32_bf16 v56, v58, v98
    v_dot2c_f32_bf16 v60, v62, v98
    v_dot2c_f32_bf16 v64, v66, v98
    v_dot2c_f32_bf16 v68, v70, v98
    v_dot2c_f32_bf16 v72, v74, v98
    v_dot2c_f32_bf16 v76, v78, v98
    v_dot2c_f32_bf16 v80, v82, v98
    v_dot2c_f32_bf16 v84, v86, v98
    v_dot2c_f32_bf16 v88, v90, v98
    v_dot2c_f32_bf16 v92, v94, v98
    v_dot2c_f32_bf16 v8, v11, v99
    v_dot2c_f32_bf16 v12, v15, v99
    v_dot2c_f32_bf16 v16, v19, v99
    v_dot2c_f32_bf16 v20, v23, v99
    v_dot2c_f32_bf16 v24, v27, v99
    v_dot2c_f32_bf16 v28, v31, v99
    v_dot2c_f32_bf16 v32, v35, v99
    v_dot2c_f32_bf16 v36, v39, v99
    v_dot2c_f32_bf16 v40, v43, v99
    v_dot2c_f32_bf16 v44, v47, v99
    v_dot2c_f32_bf16 v48, v51, v99
    v_dot2c_f32_bf16 v52, v55, v99
    v_dot2c_f32_bf16 v56, v59, v99
    v_dot2c_f32_bf16 v60, v63, v99
    v_dot2c_f32_bf16 v64, v67, v99
    v_dot2c_f32_bf16 v68, v71, v99
    v_dot2c_f32_bf16 v72, v75, v99
    v_dot2c_f32_bf16 v76, v79, v99
    v_dot2c_f32_bf16 v80, v83, v99
    v_dot2c_f32_bf16 v84, v87, v99
    v_dot2c_f32_bf16 v88, v91, v99
    v_dot2c_f32_bf16 v92, v95, v99
    v_add_f32_dpp v8, v8, v8 row_ror:8 row_mask:0xf bank_mask:0x3
    v_add_f32_dpp v8, v12, v12 row_ror:8 row_mask:0xf bank_mask:0xc
    v_add_f32_dpp v16, v16, v16 row_ror:8 row_mask:0xf bank_mask:0x3
    v_add_f32_dpp v16, v20, v20 row_ror:8 row_mask:0xf bank_mask:0xc
    v_add_f32_dpp v24, v24, v24 row_ror:8 row_mask:0xf bank_mask:0x3
    v_add_f32_dpp v24, v28, v28 row_ror:8 row_mask:0xf bank_mask:0xc
    v_add_f32_dpp v32, v32, v32 row_ror:8 row_mask:0xf bank_mask:0x3
    v_add_f32_dpp v32, v36, v36 row_ror:8 row_mask:0xf bank_mask:0xc
    v_add_f32_dpp v40, v40, v40 row_ror:8 row_mask:0xf bank_mask:0x3
    v_add_f32_dpp v40, v44, v44 row_ror:8 row_mask:0xf bank_mask:0xc
    v_add_f32_dpp v48, v48, v48 row_ror:8 row_mask:0xf bank_mask:0x3
    v_add_f32_dpp v48, v52, v52 row_ror:8 row_mask:0xf bank_mask:0xc
    v_add_f32_dpp v56, v56, v56 row_ror:8 row_mask:0xf bank_mask:0x3
    v_add_f32_dpp v56, v60, v60 row_ror:8 row_mask:0xf bank_mask:0xc
    v_add_f32_dpp v64, v64, v64 row_ror:8 row_mask:0xf bank_mask:0x3
    v_add_f32_dpp v64, v68, v68 row_ror:8 row_mask:0xf bank_mask:0xc
    v_add_f32_dpp v72, v72, v72 row_ror:8 row_mask:0xf bank_mask:0x3
    v_add_f32_dpp v72, v76, v76 row_ror:8 row_mask:0xf bank_mask:0xc
    v_add_f32_dpp v80, v80, v80 row_ror:8 row_mask:0xf bank_mask:0x3
    v_add_f32_dpp v80, v84, v84 row_ror:8 row_mask:0xf bank_mask:0xc
    v_add_f32_dpp v88, v88, v88 row_ror:8 row_mask:0xf bank_mask:0x3
    v_add_f32_dpp v88, v92, v92 row_ror:8 row_mask:0xf bank_mask:0xc
    v_add_f32_dpp v8, v8, v8 row_half_mirror row_mask:0xf bank_mask:0x5
    v_add_f32_dpp v8, v16, v16 row_half_mirror row_mask:0xf bank_mask:0xa
    v_add_f32_dpp v24, v24, v24 row_half_mirror row_mask:0xf bank_mask:0x5
    v_add_f32_dpp v24, v32, v32 row_half_mirror row_mask:0xf bank_mask:0xa
    v_add_f32_dpp v40, v40, v40 row_half_mirror row_mask:0xf bank_mask:0x5
    v_add_f32_dpp v40, v48, v48 row_half_mirror row_mask:0xf bank_mask:0xa
    v_add_f32_dpp v56, v56, v56 row_half_mirror row_mask:0xf bank_mask:0x5
    v_add_f32_dpp v56, v64, v64 row_half_mirror row_mask:0xf bank_mask:0xa
    v_add_f32_dpp v72, v72, v72 row_half_mirror row_mask:0xf bank_mask:0x5
    v_add_f32_dpp v72, v80, v80 row_half_mirror row_mask:0xf bank_mask:0xa
    v_add_f32_dpp v88, v88, v88 row_half_mirror row_mask:0xf bank_mask:0xf
    v_add_f32_dpp v8, v8, v8 quad_perm:[1,0,3,2] row_mask:0xf bank_mask:0xf
    v_add_f32_dpp v24, v24, v24 quad_perm:[1,0,3,2] row_mask:0xf bank_mask:0xf
    v_add_f32_dpp v40, v40, v40 quad_perm:[1,0,3,2] row_mask:0xf bank_mask:0xf
    v_add_f32_dpp v56, v56, v56 quad_perm:[1,0,3,2] row_mask:0xf bank_mask:0xf
    v_add_f32_dpp v72, v72, v72 quad_perm:[1,0,3,2] row_mask:0xf bank_mask:0xf
    v_add_f32_dpp v88, v88, v88 quad_perm:[1,0,3,2] row_mask:0xf bank_mask:0xf
    v_add_f32_dpp v8, v8, v8 quad_perm:[2,3,0,1] row_mask:0xf bank_mask:0xf
    v_add_f32_dpp v24, v24, v24 quad_perm:[2,3,0,1] row_mask:0xf bank_mask:0xf
    v_add_f32_dpp v40, v40, v40 quad_perm:[2,3,0,1] row_mask:0xf bank_mask:0xf
    v_add_f32_dpp v56, v56, v56 quad_perm:[2,3,0,1] row_mask:0xf bank_mask:0xf
    v_add_f32_dpp v72, v72, v72 quad_perm:[2,3,0,1] row_mask:0xf bank_mask:0xf
    v_add_f32_dpp v88, v88, v88 quad_perm:[2,3,0,1] row_mask:0xf bank_mask:0xf
    v_cndmask_b32 v96, v8, v24, s[52:53]
    v_cndmask_b32 v96, v96, v40, s[54:55]
    v_cndmask_b32 v96, v96, v56, s[56:57]
    v_cndmask_b32 v97, v72, v88, s[52:53]
    v_mov_b32 v101, 4286578688
    v_cvt_pk_bf16_f32 v100, v96, v97
    v_lshlrev_b32 v96, 16, v100
    v_and_b32 v97, 0xffff0000, v100
    v_mul_f32 v96, s62, v96
    v_mul_f32 v97, s62, v97
    v_cvt_pk_bf16_f32 v100, v96, v97
    v_lshlrev_b32 v96, 16, v100
    v_and_b32 v97, 0xffff0000, v100
    v_cndmask_b32 v97, v101, v97, s[58:59]
    v_max_f32 v100, v96, v97
    ds_write_b32 v104, v96 offset:768
    s_mov_b64 exec, s[60:61]
    ds_write_b32 v105, v97 offset:1024
    s_mov_b64 exec, -1
    s_nop 1
    v_max_f32_dpp v100, v100, v100 row_ror:8 row_mask:0xf bank_mask:0xf
    s_nop 1
    v_max_f32_dpp v100, v100, v100 row_ror:4 row_mask:0xf bank_mask:0xf
    s_nop 1
    v_max_f32_dpp v100, v100, v100 row_ror:2 row_mask:0xf bank_mask:0xf
    s_nop 1
    v_max_f32_dpp v100, v100, v100 row_ror:1 row_mask:0xf bank_mask:0xf
    s_nop 1
    v_max_f32_dpp v100, v100, v100 row_bcast:15 row_mask:0xa bank_mask:0xf
    s_nop 1
    v_max_f32_dpp v100, v100, v100 row_bcast:31 row_mask:0xc bank_mask:0xf
    s_nop 0
    v_readlane_b32 s40, v100, 63
    v_mov_b32 v99, 1
    s_mov_b32 s36, 0
    v_subrev_f32 v96, s40, v96
    v_subrev_f32 v97, s40, v97
    v_mul_f32 v96, s63, v96
    v_mul_f32 v97, s63, v97
    v_exp_f32 v96, v96
    v_exp_f32 v97, v97
    s_mov_b32 s37, 0x80000000
    v_add_f32 v101, v96, v97
    s_nop 1
    v_add_f32_dpp v101, v101, v101 row_ror:8 row_mask:0xf bank_mask:0xf
    s_nop 1
    v_add_f32_dpp v101, v101, v101 row_ror:4 row_mask:0xf bank_mask:0xf
    s_nop 1
    v_add_f32_dpp v101, v101, v101 row_ror:2 row_mask:0xf bank_mask:0xf
    s_nop 1
    v_add_f32_dpp v101, v101, v101 row_ror:1 row_mask:0xf bank_mask:0xf
    s_nop 1
    v_add_f32_dpp v101, v101, v101 row_bcast:15 row_mask:0xa bank_mask:0xf
    s_nop 1
    v_add_f32_dpp v101, v101, v101 row_bcast:31 row_mask:0xc bank_mask:0xf
    s_nop 0
    s_mov_b64 exec, s[36:37]
    ds_write_b64 v107, v[100:101] offset:64
    ds_add_rtn_u32 v99, v4, v99 offset:4
    s_waitcnt lgkmcnt(0)
    v_readlane_b32 s2, v99, 63
    s_mov_b64 exec, -1
    s_cmp_eq_u32 s2, 7
    s_cbranch_scc0 L_wo
    v_and_b32 v98, 7, v0
    v_lshlrev_b32 v98, 3, v98
    ds_read_b64 v[100:101], v98 offset:64
    s_lshl_b32 s42, s34, 7
    s_add_u32 s42, s42, 58368
    s_lshl_b32 s43, s35, 3
    s_add_u32 s43, s43, s42
    v_mov_b32 v103, 1
    s_waitcnt lgkmcnt(0)
    v_mov_b32 v102, v100
    s_nop 1
    v_max_f32_dpp v102, v102, v102 row_ror:4 row_mask:0xf bank_mask:0xf
    s_nop 1
    v_max_f32_dpp v102, v102, v102 row_ror:2 row_mask:0xf bank_mask:0xf
    s_nop 1
    v_max_f32_dpp v102, v102, v102 row_ror:1 row_mask:0xf bank_mask:0xf
    s_mov_b64 exec, 1
    ds_write_b64 v4, v[102:103] offset:16
    s_mov_b64 exec, -1
    v_sub_f32 v100, v100, v102
    v_mul_f32 v100, s63, v100
    v_exp_f32 v100, v100
    v_readfirstlane_b32 s40, v102
    v_mul_f32 v101, v100, v101
    s_nop 1
    v_add_f32_dpp v101, v101, v101 row_ror:4 row_mask:0xf bank_mask:0xf
    s_nop 1
    v_add_f32_dpp v101, v101, v101 row_ror:2 row_mask:0xf bank_mask:0xf
    s_nop 1
    v_add_f32_dpp v101, v101, v101 row_ror:1 row_mask:0xf bank_mask:0xf
    s_nop 0
    v_readfirstlane_b32 s41, v101
    s_min_u32 s40, s40, 0xfffffffe
    s_min_u32 s41, s41, 0xfffffffe
    s_atomic_swap_x2 s[40:41], s[30:31], s43
    s_waitcnt lgkmcnt(0)
    s_branch L_wo
L_qwave:
    s_load_dword s98, s[30:31], 44032
    s_waitcnt lgkmcnt(0)
    s_add_u32 s98, s98, 2654435769
    s_mov_b32 s99, s98
    s_and_b32 s84, s34, 7
    s_lshl_b32 s84, s84, 7
    s_add_u32 s84, s84, 43008
    s_mov_b32 s3, 0
L_clr_4:
    s_cmp_ge_u32 s3, 8
    s_cbranch_scc1 L_clr_4_g
    s_load_dwordx16 s[52:67], s[30:31], s84
    s_load_dwordx16 s[68:83], s[30:31], s84 offset:64
    s_add_u32 s84, s84, 128
    s_cmp_ge_u32 s84, 44032
    s_cbranch_scc0 L_clr_4_w
    s_sub_u32 s84, s84, 1024
    s_branch L_clr_4_w
L_clr_4_g:
    s_sleep 64
    s_load_dwordx16 s[52:67], s[30:31], s84 glc
    s_load_dwordx16 s[68:83], s[30:31], s84 offset:64 glc
L_clr_4_w:
    s_add_u32 s3, s3, 1
    s_waitcnt lgkmcnt(0)
    s_cmp_gt_u32 s3, 4194304
    s_cbranch_scc1 L_fin
    s_xor_b64 s[86:87], s[52:53], s[98:99]
    s_xor_b64 s[54:55], s[54:55], s[98:99]
    s_or_b64 s[86:87], s[86:87], s[54:55]
    s_xor_b64 s[56:57], s[56:57], s[98:99]
    s_or_b64 s[86:87], s[86:87], s[56:57]
    s_xor_b64 s[58:59], s[58:59], s[98:99]
    s_or_b64 s[86:87], s[86:87], s[58:59]
    s_xor_b64 s[60:61], s[60:61], s[98:99]
    s_or_b64 s[86:87], s[86:87], s[60:61]
    s_xor_b64 s[62:63], s[62:63], s[98:99]
    s_or_b64 s[86:87], s[86:87], s[62:63]
    s_xor_b64 s[64:65], s[64:65], s[98:99]
    s_or_b64 s[86:87], s[86:87], s[64:65]
    s_xor_b64 s[66:67], s[66:67], s[98:99]
    s_or_b64 s[86:87], s[86:87], s[66:67]
    s_xor_b64 s[68:69], s[68:69], s[98:99]
    s_or_b64 s[86:87], s[86:87], s[68:69]
    s_xor_b64 s[70:71], s[70:71], s[98:99]
    s_or_b64 s[86:87], s[86:87], s[70:71]
    s_xor_b64 s[72:73], s[72:73], s[98:99]
    s_or_b64 s[86:87], s[86:87], s[72:73]
    s_xor_b64 s[74:75], s[74:75], s[98:99]
    s_or_b64 s[86:87], s[86:87], s[74:75]
    s_xor_b64 s[76:77], s[76:77], s[98:99]
    s_or_b64 s[86:87], s[86:87], s[76:77]
    s_xor_b64 s[78:79], s[78:79], s[98:99]
    s_or_b64 s[86:87], s[86:87], s[78:79]
    s_xor_b64 s[80:81], s[80:81], s[98:99]
    s_or_b64 s[86:87], s[86:87], s[80:81]
    s_xor_b64 s[82:83], s[82:83], s[98:99]
    s_or_b64 s[86:87], s[86:87], s[82:83]
    s_cbranch_scc0 L_clr_4_ok
    s_sleep 16
    s_branch L_clr_4
L_clr_4_ok:
    v_mov_b32 v5, 1
    s_mov_b64 exec, 1
    ds_write_b32 v4, v5 offset:40
    s_mov_b64 exec, -1
    s_lshl_b32 s2, s34, 8
    s_add_u32 s2, s2, 45056
    s_mov_b32 s20, s2
    v_lshlrev_b32 v6, 2, v0
    s_mov_b32 s3, 0
L_lw_5:
    ds_read_b32 v5, v4 offset:44
    s_add_u32 s3, s3, 1
    s_cmp_gt_u32 s3, 4194304
    s_cbranch_scc1 L_fin
    s_waitcnt lgkmcnt(0)
    v_readfirstlane_b32 s2, v5
    s_cmp_ge_u32 s2, 8
    s_cbranch_scc1 L_lw_5_ok
    s_sleep 2
    s_branch L_lw_5
L_lw_5_ok:
    s_mov_b32 s2, s20
    s_mov_b32 s3, 0
L_qf_3:
    s_load_dwordx16 s[36:51], s[30:31], s2 offset:0 glc
    s_load_dwordx16 s[52:67], s[30:31], s2 offset:64 glc
    s_load_dwordx16 s[68:83], s[30:31], s2 offset:128 glc
    s_load_dwordx16 s[84:99], s[30:31], s2 offset:192 glc
    s_add_u32 s3, s3, 1
    s_waitcnt lgkmcnt(0)
    s_cmp_gt_u32 s3, 4194304
    s_cbranch_scc1 L_fin
    s_max_u32 vcc_lo, s36, s99
    s_cmp_eq_u32 vcc_lo, -1
    s_cbranch_scc0 L_qf_3_pre
    s_sleep 10
    s_branch L_qf_3
L_qf_3_pre:
    v_writelane_b32 v7, s36, 0
    v_writelane_b32 v7, s37, 1
    v_writelane_b32 v7, s38, 2
    v_writelane_b32 v7, s39, 3
    v_writelane_b32 v7, s40, 4
    v_writelane_b32 v7, s41, 5
    v_writelane_b32 v7, s42, 6
    v_writelane_b32 v7, s43, 7
    v_writelane_b32 v7, s44, 8
    v_writelane_b32 v7, s45, 9
    v_writelane_b32 v7, s46, 10
    v_writelane_b32 v7, s47, 11
    v_writelane_b32 v7, s48, 12
    v_writelane_b32 v7, s49, 13
    v_writelane_b32 v7, s50, 14
    v_writelane_b32 v7, s51, 15
    v_writelane_b32 v7, s52, 16
    v_writelane_b32 v7, s53, 17
    v_writelane_b32 v7, s54, 18
    v_writelane_b32 v7, s55, 19
    v_writelane_b32 v7, s56, 20
    v_writelane_b32 v7, s57, 21
    v_writelane_b32 v7, s58, 22
    v_writelane_b32 v7, s59, 23
    v_writelane_b32 v7, s60, 24
    v_writelane_b32 v7, s61, 25
    v_writelane_b32 v7, s62, 26
    v_writelane_b32 v7, s63, 27
    v_writelane_b32 v7, s64, 28
    v_writelane_b32 v7, s65, 29
    v_writelane_b32 v7, s66, 30
    v_writelane_b32 v7, s67, 31
    v_writelane_b32 v7, s68, 32
    v_writelane_b32 v7, s69, 33
    v_writelane_b32 v7, s70, 34
    v_writelane_b32 v7, s71, 35
    v_writelane_b32 v7, s72, 36
    v_writelane_b32 v7, s73, 37
    v_writelane_b32 v7, s74, 38
    v_writelane_b32 v7, s75, 39
    v_writelane_b32 v7, s76, 40
    v_writelane_b32 v7, s77, 41
    v_writelane_b32 v7, s78, 42
    v_writelane_b32 v7, s79, 43
    v_writelane_b32 v7, s80, 44
    v_writelane_b32 v7, s81, 45
    v_writelane_b32 v7, s82, 46
    v_writelane_b32 v7, s83, 47
    v_writelane_b32 v7, s84, 48
    v_writelane_b32 v7, s85, 49
    v_writelane_b32 v7, s86, 50
    v_writelane_b32 v7, s87, 51
    v_writelane_b32 v7, s88, 52
    v_writelane_b32 v7, s89, 53
    v_writelane_b32 v7, s90, 54
    v_writelane_b32 v7, s91, 55
    v_writelane_b32 v7, s92, 56
    v_writelane_b32 v7, s93, 57
    v_writelane_b32 v7, s94, 58
    v_writelane_b32 v7, s95, 59
    v_writelane_b32 v7, s96, 60
    v_writelane_b32 v7, s97, 61
    v_writelane_b32 v7, s98, 62
    v_writelane_b32 v7, s99, 63
    v_cmp_eq_u32 vcc, -1, v7
    s_cbranch_vccnz L_qf_3
    ds_write_b32 v6, v7 offset:128
    v_mov_b32 v5, 1
    s_mov_b64 exec, 1
    ds_write_b32 v4, v5 offset:0
    s_mov_b64 exec, -1
    s_branch L_kcomp
L_sec_v_7:
    s_mov_b32 s44, s30
    s_mov_b32 s45, s31
    s_mov_b32 s46, 270848
    s_mov_b32 s47, 0x20000
    v_mov_b32 v100, 0
    v_mov_b32 v101, 1
    s_mov_b64 exec, 1
    ds_add_u32 v100, v101 offset:8
    s_mov_b64 exec, -1
    s_setprio 3
    v_and_b32 v101, 1, v0
    v_lshlrev_b32 v101, 4, v101
    v_mov_b32 v102, 0xffff
    v_lshlrev_b32 v102, v101, v102
    v_bfe_u32 v101, v0, 1, 2
    v_cmp_eq_u32 vcc, 0, v101
    s_nop 1
    v_cndmask_b32 v4, 0, v102, vcc
    v_cmp_eq_u32 vcc, 1, v101
    s_nop 1
    v_cndmask_b32 v5, 0, v102, vcc
    v_cmp_eq_u32 vcc, 2, v101
    s_nop 1
    v_cndmask_b32 v6, 0, v102, vcc
    v_cmp_eq_u32 vcc, 3, v101
    s_nop 1
    v_cndmask_b32 v7, 0, v102, vcc
    s_mul_i32 s2, s42, 384
    v_lshl_add_u32 v103, v1, 2, v2
    v_lshl_add_u32 v103, v103, 2, s2
    v_min_u32 v108, 7, v1
    v_lshl_add_u32 v108, v108, 2, v2
    v_lshl_add_u32 v108, v108, 2, s2
    s_lshl_b32 s2, s42, 9
    v_lshlrev_b32 v124, 5, v1
    v_lshl_add_u32 v124, v2, 4, v124
    v_add_u32 v124, s2, v124
    v_and_b32 v126, 31, v0
    v_lshlrev_b32 v126, 4, v126
    v_lshrrev_b32 v102, 5, v0
    v_lshl_add_u32 v125, v102, 11, v126
    v_lshl_add_u32 v126, v102, 3, v126
    s_mul_i32 s40, s34, 3072
    s_lshl_b32 s2, s35, 9
    s_add_u32 s40, s40, s2
    s_add_u32 s40, s40, 62464
    s_mov_b32 s3, 0
L_vw_ml:
    ds_read_b64 v[104:105], v100 offset:16
    s_add_u32 s3, s3, 1
    s_cmp_gt_u32 s3, 4194304
    s_cbranch_scc1 L_fin
    s_waitcnt lgkmcnt(0)
    v_readfirstlane_b32 s2, v105
    s_cmp_eq_u32 s2, 1
    s_cbranch_scc1 L_vw_ml_ok
    s_sleep 2
    s_branch L_vw_ml
L_vw_ml_ok:
    ds_read_b32 v106, v103 offset:768
    ds_read_b32 v107, v108 offset:1024
    s_mov_b32 s41, 1069066811
    s_waitcnt lgkmcnt(0)
    v_sub_f32 v106, v106, v104
    v_sub_f32 v107, v107, v104
    v_mul_f32 v106, s41, v106
    v_mul_f32 v107, s41, v107
    v_exp_f32 v106, v106
    v_exp_f32 v107, v107
    s_nop 0
    v_cvt_pk_bf16_f32 v106, v106, v106
    v_cvt_pk_bf16_f32 v107, v107, v107
    v_mov_b32 v101, 1
    s_mov_b32 s36, -1
    s_mov_b32 s37, 0
    v_and_b32_dpp v116, v106, v4 row_newbcast:0 row_mask:0xf bank_mask:0xf
    v_and_b32_dpp v117, v106, v5 row_newbcast:0 row_mask:0xf bank_mask:0xf
    v_and_b32_dpp v118, v106, v6 row_newbcast:0 row_mask:0xf bank_mask:0xf
    v_and_b32_dpp v119, v106, v7 row_newbcast:0 row_mask:0xf bank_mask:0xf
    v_and_b32_dpp v120, v106, v4 row_newbcast:1 row_mask:0xf bank_mask:0xf
    v_and_b32_dpp v121, v106, v5 row_newbcast:1 row_mask:0xf bank_mask:0xf
    v_and_b32_dpp v122, v106, v6 row_newbcast:1 row_mask:0xf bank_mask:0xf
    v_and_b32_dpp v123, v106, v7 row_newbcast:1 row_mask:0xf bank_mask:0xf
    s_waitcnt vmcnt(21)
    v_mfma_f32_16x16x32_bf16 v[96:99], v[116:119], v[8:11], 0
    v_and_b32_dpp v116, v106, v4 row_newbcast:2 row_mask:0xf bank_mask:0xf
    v_and_b32_dpp v117, v106, v5 row_newbcast:2 row_mask:0xf bank_mask:0xf
    v_and_b32_dpp v118, v106, v6 row_newbcast:2 row_mask:0xf bank_mask:0xf
    v_and_b32_dpp v119, v106, v7 row_newbcast:2 row_mask:0xf bank_mask:0xf
    s_waitcnt vmcnt(20)
    v_mfma_f32_16x16x32_bf16 v[96:99], v[120:123], v[12:15], v[96:99]
    v_and_b32_dpp v120, v106, v4 row_newbcast:3 row_mask:0xf bank_mask:0xf
    v_and_b32_dpp v121, v106, v5 row_newbcast:3 row_mask:0xf bank_mask:0xf
    v_and_b32_dpp v122, v106, v6 row_newbcast:3 row_mask:0xf bank_mask:0xf
    v_and_b32_dpp v123, v106, v7 row_newbcast:3 row_mask:0xf bank_mask:0xf
    s_waitcnt vmcnt(19)
    v_mfma_f32_16x16x32_bf16 v[96:99], v[116:119], v[16:19], v[96:99]
    v_and_b32_dpp v116, v106, v4 row_newbcast:4 row_mask:0xf bank_mask:0xf
    v_and_b32_dpp v117, v106, v5 row_newbcast:4 row_mask:0xf bank_mask:0xf
    v_and_b32_dpp v118, v106, v6 row_newbcast:4 row_mask:0xf bank_mask:0xf
    v_and_b32_dpp v119, v106, v7 row_newbcast:4 row_mask:0xf bank_mask:0xf
    s_waitcnt vmcnt(18)
    v_mfma_f32_16x16x32_bf16 v[96:99], v[120:123], v[20:23], v[96:99]
    v_and_b32_dpp v120, v106, v4 row_newbcast:5 row_mask:0xf bank_mask:0xf
    v_and_b32_dpp v121, v106, v5 row_newbcast:5 row_mask:0xf bank_mask:0xf
    v_and_b32_dpp v122, v106, v6 row_newbcast:5 row_mask:0xf bank_mask:0xf
    v_and_b32_dpp v123, v106, v7 row_newbcast:5 row_mask:0xf bank_mask:0xf
    s_waitcnt vmcnt(17)
    v_mfma_f32_16x16x32_bf16 v[96:99], v[116:119], v[24:27], v[96:99]
    v_and_b32_dpp v116, v106, v4 row_newbcast:6 row_mask:0xf bank_mask:0xf
    v_and_b32_dpp v117, v106, v5 row_newbcast:6 row_mask:0xf bank_mask:0xf
    v_and_b32_dpp v118, v106, v6 row_newbcast:6 row_mask:0xf bank_mask:0xf
    v_and_b32_dpp v119, v106, v7 row_newbcast:6 row_mask:0xf bank_mask:0xf
    s_waitcnt vmcnt(16)
    v_mfma_f32_16x16x32_bf16 v[96:99], v[120:123], v[28:31], v[96:99]
    v_and_b32_dpp v120, v106, v4 row_newbcast:7 row_mask:0xf bank_mask:0xf
    v_and_b32_dpp v121, v106, v5 row_newbcast:7 row_mask:0xf bank_mask:0xf
    v_and_b32_dpp v122, v106, v6 row_newbcast:7 row_mask:0xf bank_mask:0xf
    v_and_b32_dpp v123, v106, v7 row_newbcast:7 row_mask:0xf bank_mask:0xf
    s_waitcnt vmcnt(15)
    v_mfma_f32_16x16x32_bf16 v[96:99], v[116:119], v[32:35], v[96:99]
    v_and_b32_dpp v116, v106, v4 row_newbcast:8 row_mask:0xf bank_mask:0xf
    v_and_b32_dpp v117, v106, v5 row_newbcast:8 row_mask:0xf bank_mask:0xf
    v_and_b32_dpp v118, v106, v6 row_newbcast:8 row_mask:0xf bank_mask:0xf
    v_and_b32_dpp v119, v106, v7 row_newbcast:8 row_mask:0xf bank_mask:0xf
    s_waitcnt vmcnt(14)
    v_mfma_f32_16x16x32_bf16 v[96:99], v[120:123], v[36:39], v[96:99]
    v_and_b32_dpp v120, v106, v4 row_newbcast:9 row_mask:0xf bank_mask:0xf
    v_and_b32_dpp v121, v106, v5 row_newbcast:9 row_mask:0xf bank_mask:0xf
    v_and_b32_dpp v122, v106, v6 row_newbcast:9 row_mask:0xf bank_mask:0xf
    v_and_b32_dpp v123, v106, v7 row_newbcast:9 row_mask:0xf bank_mask:0xf
    s_waitcnt vmcnt(13)
    v_mfma_f32_16x16x32_bf16 v[96:99], v[116:119], v[40:43], v[96:99]
    v_and_b32_dpp v116, v106, v4 row_newbcast:10 row_mask:0xf bank_mask:0xf
    v_and_b32_dpp v117, v106, v5 row_newbcast:10 row_mask:0xf bank_mask:0xf
    v_and_b32_dpp v118, v106, v6 row_newbcast:10 row_mask:0xf bank_mask:0xf
    v_and_b32_dpp v119, v106, v7 row_newbcast:10 row_mask:0xf bank_mask:0xf
    s_waitcnt vmcnt(12)
    v_mfma_f32_16x16x32_bf16 v[96:99], v[120:123], v[44:47], v[96:99]
    v_and_b32_dpp v120, v106, v4 row_newbcast:11 row_mask:0xf bank_mask:0xf
    v_and_b32_dpp v121, v106, v5 row_newbcast:11 row_mask:0xf bank_mask:0xf
    v_and_b32_dpp v122, v106, v6 row_newbcast:11 row_mask:0xf bank_mask:0xf
    v_and_b32_dpp v123, v106, v7 row_newbcast:11 row_mask:0xf bank_mask:0xf
    s_waitcnt vmcnt(11)
    v_mfma_f32_16x16x32_bf16 v[96:99], v[116:119], v[48:51], v[96:99]
    v_and_b32_dpp v116, v106, v4 row_newbcast:12 row_mask:0xf bank_mask:0xf
    v_and_b32_dpp v117, v106, v5 row_newbcast:12 row_mask:0xf bank_mask:0xf
    v_and_b32_dpp v118, v106, v6 row_newbcast:12 row_mask:0xf bank_mask:0xf
    v_and_b32_dpp v119, v106, v7 row_newbcast:12 row_mask:0xf bank_mask:0xf
    s_waitcnt vmcnt(10)
    v_mfma_f32_16x16x32_bf16 v[96:99], v[120:123], v[52:55], v[96:99]
    v_and_b32_dpp v120, v106, v4 row_newbcast:13 row_mask:0xf bank_mask:0xf
    v_and_b32_dpp v121, v106, v5 row_newbcast:13 row_mask:0xf bank_mask:0xf
    v_and_b32_dpp v122, v106, v6 row_newbcast:13 row_mask:0xf bank_mask:0xf
    v_and_b32_dpp v123, v106, v7 row_newbcast:13 row_mask:0xf bank_mask:0xf
    s_waitcnt vmcnt(9)
    v_mfma_f32_16x16x32_bf16 v[96:99], v[116:119], v[56:59], v[96:99]
    v_and_b32_dpp v116, v106, v4 row_newbcast:14 row_mask:0xf bank_mask:0xf
    v_and_b32_dpp v117, v106, v5 row_newbcast:14 row_mask:0xf bank_mask:0xf
    v_and_b32_dpp v118, v106, v6 row_newbcast:14 row_mask:0xf bank_mask:0xf
    v_and_b32_dpp v119, v106, v7 row_newbcast:14 row_mask:0xf bank_mask:0xf
    s_waitcnt vmcnt(8)
    v_mfma_f32_16x16x32_bf16 v[96:99], v[120:123], v[60:63], v[96:99]
    v_and_b32_dpp v120, v106, v4 row_newbcast:15 row_mask:0xf bank_mask:0xf
    v_and_b32_dpp v121, v106, v5 row_newbcast:15 row_mask:0xf bank_mask:0xf
    v_and_b32_dpp v122, v106, v6 row_newbcast:15 row_mask:0xf bank_mask:0xf
    v_and_b32_dpp v123, v106, v7 row_newbcast:15 row_mask:0xf bank_mask:0xf
    s_waitcnt vmcnt(7)
    v_mfma_f32_16x16x32_bf16 v[96:99], v[116:119], v[64:67], v[96:99]
    v_and_b32_dpp v116, v107, v4 row_newbcast:0 row_mask:0xf bank_mask:0xf
    v_and_b32_dpp v117, v107, v5 row_newbcast:0 row_mask:0xf bank_mask:0xf
    v_and_b32_dpp v118, v107, v6 row_newbcast:0 row_mask:0xf bank_mask:0xf
    v_and_b32_dpp v119, v107, v7 row_newbcast:0 row_mask:0xf bank_mask:0xf
    s_waitcnt vmcnt(6)
    v_mfma_f32_16x16x32_bf16 v[96:99], v[120:123], v[68:71], v[96:99]
    v_and_b32_dpp v120, v107, v4 row_newbcast:1 row_mask:0xf bank_mask:0xf
    v_and_b32_dpp v121, v107, v5 row_newbcast:1 row_mask:0xf bank_mask:0xf
    v_and_b32_dpp v122, v107, v6 row_newbcast:1 row_mask:0xf bank_mask:0xf
    v_and_b32_dpp v123, v107, v7 row_newbcast:1 row_mask:0xf bank_mask:0xf
    s_waitcnt vmcnt(5)
    v_mfma_f32_16x16x32_bf16 v[96:99], v[116:119], v[72:75], v[96:99]
    v_and_b32_dpp v116, v107, v4 row_newbcast:2 row_mask:0xf bank_mask:0xf
    v_and_b32_dpp v117, v107, v5 row_newbcast:2 row_mask:0xf bank_mask:0xf
    v_and_b32_dpp v118, v107, v6 row_newbcast:2 row_mask:0xf bank_mask:0xf
    v_and_b32_dpp v119, v107, v7 row_newbcast:2 row_mask:0xf bank_mask:0xf
    s_waitcnt vmcnt(4)
    v_mfma_f32_16x16x32_bf16 v[96:99], v[120:123], v[76:79], v[96:99]
    v_and_b32_dpp v120, v107, v4 row_newbcast:3 row_mask:0xf bank_mask:0xf
    v_and_b32_dpp v121, v107, v5 row_newbcast:3 row_mask:0xf bank_mask:0xf
    v_and_b32_dpp v122, v107, v6 row_newbcast:3 row_mask:0xf bank_mask:0xf
    v_and_b32_dpp v123, v107, v7 row_newbcast:3 row_mask:0xf bank_mask:0xf
    s_waitcnt vmcnt(3)
    v_mfma_f32_16x16x32_bf16 v[96:99], v[116:119], v[80:83], v[96:99]
    v_and_b32_dpp v116, v107, v4 row_newbcast:4 row_mask:0xf bank_mask:0xf
    v_and_b32_dpp v117, v107, v5 row_newbcast:4 row_mask:0xf bank_mask:0xf
    v_and_b32_dpp v118, v107, v6 row_newbcast:4 row_mask:0xf bank_mask:0xf
    v_and_b32_dpp v119, v107, v7 row_newbcast:4 row_mask:0xf bank_mask:0xf
    s_waitcnt vmcnt(2)
    v_mfma_f32_16x16x32_bf16 v[96:99], v[120:123], v[84:87], v[96:99]
    v_and_b32_dpp v120, v107, v4 row_newbcast:5 row_mask:0xf bank_mask:0xf
    v_and_b32_dpp v121, v107, v5 row_newbcast:5 row_mask:0xf bank_mask:0xf
    v_and_b32_dpp v122, v107, v6 row_newbcast:5 row_mask:0xf bank_mask:0xf
    v_and_b32_dpp v123, v107, v7 row_newbcast:5 row_mask:0xf bank_mask:0xf
    s_waitcnt vmcnt(1)
    v_mfma_f32_16x16x32_bf16 v[96:99], v[116:119], v[88:91], v[96:99]
    s_waitcnt vmcnt(0)
    v_mfma_f32_16x16x32_bf16 v[96:99], v[120:123], v[92:95], v[96:99]
    s_mov_b64 exec, s[36:37]
    s_nop 6
    ds_write_b128 v124, v[96:99] offset:3840
    s_mov_b64 exec, 1
    ds_add_rtn_u32 v101, v100, v101 offset:12
    s_mov_b64 exec, s[36:37]
    s_waitcnt lgkmcnt(0)
    v_readfirstlane_b32 s2, v101
    s_cmp_eq_u32 s2, 7
    s_cbranch_scc0 L_fin
    s_mov_b64 exec, -1
    ds_read_b128 v[8:11], v125 offset:3840
    ds_read_b128 v[12:15], v125 offset:4352
    ds_read_b128 v[16:19], v125 offset:4864
    ds_read_b128 v[20:23], v125 offset:5376
    v_mov_b32 v101, 1
    s_waitcnt lgkmcnt(2)
    v_pk_add_f32 v[8:9], v[8:9], v[12:13]
    v_pk_add_f32 v[10:11], v[10:11], v[14:15]
    s_waitcnt lgkmcnt(1)
    v_pk_add_f32 v[8:9], v[8:9], v[16:17]
    v_pk_add_f32 v[10:11], v[10:11], v[18:19]
    s_waitcnt lgkmcnt(0)
    v_pk_add_f32 v[8:9], v[8:9], v[20:21]
    v_pk_add_f32 v[10:11], v[10:11], v[22:23]
    s_nop 1
    v_permlane32_swap_b32 v8, v10
    v_permlane32_swap_b32 v9, v11
    v_pk_add_f32 v[8:9], v[8:9], v[10:11]
    buffer_store_dwordx2 v[8:9], v126, s[44:47], s40 offen sc1
    s_mov_b64 exec, 1
    ds_write_b32 v100, v101 offset:32
    s_branch L_fin
L_wo:
    s_and_b32 s2, s34, 1
    s_mul_i32 s2, s2, 6
    s_add_u32 s42, s2, s35
    s_cmp_ge_u32 s42, 10
    s_cbranch_scc1 L_fin
    s_load_dwordx2 s[36:37], s[0:1], 32
    s_lshr_b32 s43, s34, 1
    v_lshrrev_b32 v8, 3, v0
    v_and_b32 v9, 7, v0
    v_mul_u32_u24 v10, 5120, v8
    v_lshl_add_u32 v10, v9, 4, v10
    s_lshl_b32 s40, s43, 8
    s_lshl_b32 s2, s33, 5
    s_add_u32 s40, s40, s2
    s_mul_i32 s40, s40, 1280
    s_lshl_b32 s2, s42, 7
    s_add_u32 s40, s40, s2
    s_mov_b32 s38, 5242880
    s_mov_b32 s39, 0x20000
    v_mov_b32 v11, 0
    s_mov_b32 s44, s30
    s_mov_b32 s45, s31
    s_mov_b32 s46, 270848
    s_mov_b32 s47, 0x20000
    v_and_b32 v12, 1, v0
    v_lshlrev_b32 v12, 4, v12
    v_mov_b32 v13, 0xffff
    v_lshlrev_b32 v13, v12, v13
    v_bfe_u32 v12, v0, 1, 2
    v_cmp_eq_u32 vcc, 0, v12
    s_nop 1
    v_cndmask_b32 v4, 0, v13, vcc
    v_cmp_eq_u32 vcc, 1, v12
    s_nop 1
    v_cndmask_b32 v5, 0, v13, vcc
    v_cmp_eq_u32 vcc, 2, v12
    s_nop 1
    v_cndmask_b32 v6, 0, v13, vcc
    v_cmp_eq_u32 vcc, 3, v12
    s_nop 1
    v_cndmask_b32 v7, 0, v13, vcc
    s_lshl_b32 s41, s43, 1
    s_lshr_b32 s2, s33, 2
    s_add_u32 s41, s41, s2
    s_mul_i32 s41, s41, 3072
    s_and_b32 s2, s33, 3
    s_lshl_b32 s2, s2, 7
    s_add_u32 s41, s41, s2
    s_add_u32 s41, s41, 62464
    v_lshlrev_b32 v12, 4, v8
    v_bfe_u32 v13, v0, 3, 1
    s_lshl_b32 s2, s33, 1
    v_add_u32 v13, s2, v13
    v_lshlrev_b32 v13, 8, v13
    v_lshl_add_u32 v13, v9, 5, v13
    v_and_b32 v14, 1, v2
    v_lshl_add_u32 v13, v14, 4, v13
    v_lshlrev_b32 v14, 2, v0
    s_mov_b32 s3, 0
L_lw_9:
    ds_read_b32 v15, v11 offset:8
    s_add_u32 s3, s3, 1
    s_cmp_gt_u32 s3, 4194304
    s_cbranch_scc1 L_fin
    s_waitcnt lgkmcnt(0)
    v_readfirstlane_b32 s2, v15
    s_cmp_eq_u32 s2, 8
    s_cbranch_scc1 L_lw_9_ok
    s_sleep 2
    s_branch L_lw_9
L_lw_9_ok:
    buffer_load_dwordx4 v[16:19], v10, s[36:39], s40 offen offset:0 nt
    buffer_load_dwordx4 v[20:23], v10, s[36:39], s40 offen offset:1280 nt
    buffer_load_dwordx4 v[24:27], v10, s[36:39], s40 offen offset:2560 nt
    buffer_load_dwordx4 v[28:31], v10, s[36:39], s40 offen offset:3840 nt
    s_mul_i32 s40, s43, 2560
    s_lshl_b32 s2, s42, 8
    s_add_u32 s40, s40, s2
    s_add_u32 s40, s40, 160768
    s_mov_b32 s48, 0x00ff00ff
    s_mov_b32 s49, 0xff00ff00
    s_lshl_b32 s50, s43, 1
    s_lshr_b32 s2, s33, 2
    s_add_u32 s50, s50, s2
    s_lshl_b32 s50, s50, 7
    s_add_u32 s50, s50, 58368
    s_mov_b32 s3, 0
L_mlpoll_10:
    s_load_dwordx16 s[52:67], s[30:31], s50 glc
    s_add_u32 s3, s3, 1
    s_waitcnt lgkmcnt(0)
    s_cmp_gt_u32 s3, 4194304
    s_cbranch_scc1 L_fin
    s_max_u32 s2, s52, s53
    s_max_u32 s2, s2, s54
    s_max_u32 s2, s2, s55
    s_max_u32 s2, s2, s56
    s_max_u32 s2, s2, s57
    s_max_u32 s2, s2, s58
    s_max_u32 s2, s2, s59
    s_max_u32 s2, s2, s60
    s_max_u32 s2, s2, s61
    s_max_u32 s2, s2, s62
    s_max_u32 s2, s2, s63
    s_cmp_eq_u32 s2, -1
    s_cbranch_scc0 L_mlpoll_10_ok
    s_sleep 8
    s_branch L_mlpoll_10
L_mlpoll_10_ok:
    v_mov_b32 v61, s52
    v_max_f32 v61, s54, v61
    v_max_f32 v61, s56, v61
    v_max_f32 v61, s58, v61
    v_max_f32 v61, s60, v61
    v_max_f32 v61, s62, v61
    s_mov_b32 s2, 1069066811
    v_sub_f32 v64, s52, v61
    v_sub_f32 v66, s54, v61
    v_sub_f32 v68, s56, v61
    v_sub_f32 v70, s58, v61
    v_sub_f32 v72, s60, v61
    v_sub_f32 v74, s62, v61
    v_mul_f32 v64, s2, v64
    v_mul_f32 v66, s2, v66
    v_mul_f32 v68, s2, v68
    v_mul_f32 v70, s2, v70
    v_mul_f32 v72, s2, v72
    v_mul_f32 v74, s2, v74
    v_exp_f32 v64, v64
    v_exp_f32 v66, v66
    v_exp_f32 v68, v68
    v_exp_f32 v70, v70
    v_exp_f32 v72, v72
    v_exp_f32 v74, v74
    v_mul_f32 v61, s53, v64
    v_fma_f32 v61, s55, v66, v61
    v_fma_f32 v61, s57, v68, v61
    v_fma_f32 v61, s59, v70, v61
    v_fma_f32 v61, s61, v72, v61
    v_fma_f32 v61, s63, v74, v61
    v_rcp_f32 v62, v61
    s_nop 0
    v_fma_f32 v63, -v61, v62, 1.0
    v_fma_f32 v62, v63, v62, v62
    v_mul_f32 v64, v64, v62
    v_mul_f32 v66, v66, v62
    v_mul_f32 v68, v68, v62
    v_mul_f32 v70, v70, v62
    v_mul_f32 v72, v72, v62
    v_mul_f32 v74, v74, v62
    s_mov_b32 s3, 0
L_lw_11:
    ds_read_b32 v15, v11 offset:32
    s_add_u32 s3, s3, 1
    s_cmp_gt_u32 s3, 4194304
    s_cbranch_scc1 L_fin
    s_waitcnt lgkmcnt(0)
    v_readfirstlane_b32 s2, v15
    s_cmp_eq_u32 s2, 1
    s_cbranch_scc1 L_lw_11_ok
    s_sleep 1
    s_branch L_lw_11
L_lw_11_ok:
    v_mov_b32 v15, 1
    v_lshlrev_b32 v62, 1, v0
    s_mov_b32 s3, 0
L_ha_12:
    buffer_load_dwordx4 v[32:35], v12, s[44:47], s41 offen offset:0 sc1
    buffer_load_dwordx4 v[36:39], v12, s[44:47], s41 offen offset:512 sc1
    buffer_load_dwordx4 v[40:43], v12, s[44:47], s41 offen offset:1024 sc1
    buffer_load_dwordx4 v[44:47], v12, s[44:47], s41 offen offset:1536 sc1
    buffer_load_dwordx4 v[48:51], v12, s[44:47], s41 offen offset:2048 sc1
    buffer_load_dwordx4 v[52:55], v12, s[44:47], s41 offen offset:2560 sc1
L_ha_12_in:
    s_add_u32 s3, s3, 1
    s_cmp_gt_u32 s3, 524288
    s_waitcnt vmcnt(5)
    v_pk_mul_f32 v[104:105], v[32:33], v[64:65] op_sel_hi:[1,0]
    v_pk_mul_f32 v[106:107], v[34:35], v[64:65] op_sel_hi:[1,0]
    s_waitcnt vmcnt(4)
    v_pk_fma_f32 v[104:105], v[36:37], v[66:67], v[104:105] op_sel_hi:[1,0,1]
    v_pk_fma_f32 v[106:107], v[38:39], v[66:67], v[106:107] op_sel_hi:[1,0,1]
    s_waitcnt vmcnt(3)
    v_pk_fma_f32 v[104:105], v[40:41], v[68:69], v[104:105] op_sel_hi:[1,0,1]
    v_pk_fma_f32 v[106:107], v[42:43], v[68:69], v[106:107] op_sel_hi:[1,0,1]
    s_waitcnt vmcnt(2)
    v_pk_fma_f32 v[104:105], v[44:45], v[70:71], v[104:105] op_sel_hi:[1,0,1]
    v_pk_fma_f32 v[106:107], v[46:47], v[70:71], v[106:107] op_sel_hi:[1,0,1]
    s_waitcnt vmcnt(1)
    v_pk_fma_f32 v[104:105], v[48:49], v[72:73], v[104:105] op_sel_hi:[1,0,1]
    v_pk_fma_f32 v[106:107], v[50:51], v[72:73], v[106:107] op_sel_hi:[1,0,1]
    s_waitcnt vmcnt(0)
    v_pk_fma_f32 v[104:105], v[52:53], v[74:75], v[104:105] op_sel_hi:[1,0,1]
    v_pk_fma_f32 v[106:107], v[54:55], v[74:75], v[106:107] op_sel_hi:[1,0,1]
    v_pk_mul_f32 v[60:61], v[104:105], v[106:107]
    v_cmp_u_f32 vcc, v60, v61
    s_cbranch_scc1 L_ha_12_ok
    s_cbranch_vccnz L_ha_12
L_ha_12_ok:
    v_cvt_pk_bf16_f32 v104, v104, v104
    v_cvt_pk_bf16_f32 v105, v105, v105
    v_cvt_pk_bf16_f32 v106, v106, v106
    v_cvt_pk_bf16_f32 v107, v107, v107
    v_and_b32 v108, v104, v4
    v_and_b32 v109, v104, v5
    v_and_b32 v110, v104, v6
    v_and_b32 v111, v104, v7
    v_and_b32 v112, v105, v4
    v_and_b32 v113, v105, v5
    v_and_b32 v114, v105, v6
    v_and_b32 v115, v105, v7
    v_mfma_f32_16x16x32_bf16 v[56:59], v[108:111], v[16:19], 0
    v_and_b32 v116, v106, v4
    v_and_b32 v117, v106, v5
    v_and_b32 v118, v106, v6
    v_and_b32 v119, v106, v7
    v_mfma_f32_16x16x32_bf16 v[56:59], v[112:115], v[20:23], v[56:59]
    v_and_b32 v120, v107, v4
    v_and_b32 v121, v107, v5
    v_and_b32 v122, v107, v6
    v_and_b32 v123, v107, v7
    v_mfma_f32_16x16x32_bf16 v[56:59], v[116:119], v[24:27], v[56:59]
    s_nop 0
    v_mfma_f32_16x16x32_bf16 v[56:59], v[120:123], v[28:31], v[56:59]
    s_mov_b64 exec, s[48:49]
    s_nop 6
    ds_write_b128 v13, v[56:59] offset:7936
    s_mov_b64 exec, 1
    ds_add_rtn_u32 v15, v11, v15 offset:36
    s_mov_b64 exec, -1
    s_waitcnt lgkmcnt(0)
    v_readfirstlane_b32 s2, v15
    s_cmp_eq_u32 s2, 7
    s_cbranch_scc0 L_fin
    ds_read2st64_b32 v[16:17], v14 offset0:31 offset1:32
    ds_read2st64_b32 v[18:19], v14 offset0:33 offset1:34
    ds_read2st64_b32 v[20:21], v14 offset0:35 offset1:36
    ds_read2st64_b32 v[22:23], v14 offset0:37 offset1:38
    ds_read2st64_b32 v[24:25], v14 offset0:39 offset1:40
    ds_read2st64_b32 v[26:27], v14 offset0:41 offset1:42
    ds_read2st64_b32 v[28:29], v14 offset0:43 offset1:44
    ds_read2st64_b32 v[30:31], v14 offset0:45 offset1:46
    s_waitcnt lgkmcnt(6)
    v_pk_add_f32 v[16:17], v[16:17], v[18:19]
    s_waitcnt lgkmcnt(5)
    v_pk_add_f32 v[16:17], v[16:17], v[20:21]
    s_waitcnt lgkmcnt(4)
    v_pk_add_f32 v[16:17], v[16:17], v[22:23]
    s_waitcnt lgkmcnt(3)
    v_pk_add_f32 v[16:17], v[16:17], v[24:25]
    s_waitcnt lgkmcnt(2)
    v_pk_add_f32 v[16:17], v[16:17], v[26:27]
    s_waitcnt lgkmcnt(1)
    v_pk_add_f32 v[16:17], v[16:17], v[28:29]
    s_waitcnt lgkmcnt(0)
    v_pk_add_f32 v[16:17], v[16:17], v[30:31]
    v_add_f32 v16, v16, v17
    buffer_store_dword v16, v14, s[44:47], s40 offen sc1
    s_branch L_fin
L_sec_svc2_21:
    v_and_b32 v21, 1, v0
    v_lshlrev_b32 v21, 4, v21
    v_mov_b32 v22, 0xffff
    v_lshlrev_b32 v22, v21, v22
    v_bfe_u32 v21, v0, 1, 2
    v_cmp_eq_u32 vcc, 0, v21
    s_nop 1
    v_cndmask_b32 v4, 0, v22, vcc
    v_cmp_eq_u32 vcc, 1, v21
    s_nop 1
    v_cndmask_b32 v5, 0, v22, vcc
    v_cmp_eq_u32 vcc, 2, v21
    s_nop 1
    v_cndmask_b32 v6, 0, v22, vcc
    v_cmp_eq_u32 vcc, 3, v21
    s_nop 1
    v_cndmask_b32 v7, 0, v22, vcc
    s_mov_b32 s44, s30
    s_mov_b32 s45, s31
    s_mov_b32 s46, 270848
    s_mov_b32 s47, 0x20000
    v_mul_u32_u24 v29, 2560, v2
    v_lshl_add_u32 v29, v1, 4, v29
    s_lshl_b32 s2, s35, 8
    v_lshl_add_u32 v124, v1, 2, v2
    v_lshl_add_u32 v124, v124, 2, s2
    v_lshl_add_u32 v21, v8, 5, s2
    s_lshl_b32 s2, s35, 9
    v_lshrrev_b32 v22, 1, v2
    v_lshlrev_b32 v22, 8, v22
    v_lshl_add_u32 v22, v9, 5, v22
    v_and_b32 v23, 1, v2
    v_lshl_add_u32 v22, v23, 4, v22
    v_add_u32 v22, s2, v22
    s_mov_b32 s58, 0x00010001
    s_mov_b32 s59, 0x00010001
    s_mov_b32 s3, 0
L_lw_22:
    ds_read_b32 v23, v15 offset:0
    s_add_u32 s3, s3, 1
    s_cmp_gt_u32 s3, 4194304
    s_cbranch_scc1 L_fin
    s_waitcnt lgkmcnt(0)
    v_readfirstlane_b32 s2, v23
    s_cmp_eq_u32 s2, 1
    s_cbranch_scc1 L_lw_22_ok
    s_sleep 2
    s_branch L_lw_22
L_lw_22_ok:
    s_mov_b32 s41, 53248
    s_mov_b32 s42, 55808
    s_lshl_b32 s62, s35, 8
    s_add_u32 s62, s62, 160768
    s_add_u32 s63, s62, 10240
    s_add_u32 s64, s62, 20480
    s_add_u32 s65, s62, 30720
    v_lshrrev_b32 v12, 1, v29
    v_mov_b32 v10, 0x00003f80
    v_mov_b32 v11, 0x3f800000
    s_mov_b32 s36, 0x00ff00ff
    s_mov_b32 s37, 0x00ff00ff
    s_mov_b32 s3, 0
L_mods_23:
    buffer_load_ushort v25, v20, s[44:47], s41 offen sc1
    buffer_load_ushort v26, v20, s[44:47], s41 offen offset:1280 sc1
    buffer_load_ushort v27, v20, s[44:47], s42 offen sc1
    s_add_u32 s3, s3, 1
    s_cmp_gt_u32 s3, 4194304
    s_cbranch_scc1 L_fin
    s_waitcnt vmcnt(0)
    v_max3_u32 v23, v25, v26, v27
    v_cmp_eq_u32 vcc, 0xffff, v23
    s_cbranch_vccz L_mods_23_ok
    s_sleep 8
    s_branch L_mods_23
L_mods_23_ok:
    v_lshlrev_b32 v24, 16, v24
    v_lshlrev_b32 v25, 16, v25
    v_lshlrev_b32 v26, 16, v26
    v_lshlrev_b32 v27, 16, v27
    v_add_f32 v27, 1.0, v27
    v_cvt_pk_bf16_f32 v27, v27, v27
    v_and_b32 v27, 0xffff0000, v27
    v_mul_f32 v30, v25, v27
    v_mul_f32 v31, v24, v27
    v_mov_b32 v120, v27
    v_mov_b32 v121, 0
    v_mov_b32 v125, 8
    s_mov_b32 s66, 0
L_pass:
    v_cvt_pk_bf16_f32 v120, v120, v120
    ds_write_b32 v124, v120 offset:7936
    ds_read_b128 v[32:35], v21 offset:7936
    ds_read_b128 v[36:39], v21 offset:7952
    v_cvt_pk_bf16_f32 v121, v121, v121
    v_and_b32 v121, 0xffff0000, v121
    v_mul_f32 v121, v25, v121
    v_cvt_pk_bf16_f32 v121, v121, v121
    v_and_b32 v121, 0xffff0000, v121
    v_add_f32 v126, v24, v121
    v_cvt_pk_bf16_f32 v126, v126, v126
    v_and_b32 v126, 0xffff0000, v126
    v_mul_f32 v123, v126, v126
    s_nop 0
    v_add_f32_dpp v122, v126, v126 row_ror:8 row_mask:0xf bank_mask:0xf
    v_add_f32_dpp v123, v123, v123 row_ror:8 row_mask:0xf bank_mask:0xf
    s_waitcnt lgkmcnt(1)
    v_and_b32 v40, v32, v4
    v_and_b32 v41, v32, v5
    v_and_b32 v42, v32, v6
    v_and_b32 v43, v32, v7
    v_and_b32 v44, v33, v4
    v_and_b32 v45, v33, v5
    v_and_b32 v46, v33, v6
    v_and_b32 v47, v33, v7
    v_mfma_f32_16x16x32_bf16 v[16:19], v[40:43], v[56:59], 0
    v_mfma_f32_16x16x32_bf16 v[48:51], v[40:43], v[88:91], 0
    v_and_b32 v40, v34, v4
    v_and_b32 v41, v34, v5
    v_and_b32 v42, v34, v6
    v_and_b32 v43, v34, v7
    v_mfma_f32_16x16x32_bf16 v[16:19], v[44:47], v[60:63], v[16:19]
    v_mfma_f32_16x16x32_bf16 v[48:51], v[44:47], v[92:95], v[48:51]
    v_and_b32 v44, v35, v4
    v_and_b32 v45, v35, v5
    v_and_b32 v46, v35, v6
    v_and_b32 v47, v35, v7
    v_mfma_f32_16x16x32_bf16 v[16:19], v[40:43], v[64:67], v[16:19]
    v_mfma_f32_16x16x32_bf16 v[48:51], v[40:43], v[96:99], v[48:51]
    s_waitcnt lgkmcnt(0)
    v_and_b32 v40, v36, v4
    v_and_b32 v41, v36, v5
    v_and_b32 v42, v36, v6
    v_and_b32 v43, v36, v7
    v_mfma_f32_16x16x32_bf16 v[16:19], v[44:47], v[68:71], v[16:19]
    v_mfma_f32_16x16x32_bf16 v[48:51], v[44:47], v[100:103], v[48:51]
    v_and_b32 v44, v37, v4
    v_and_b32 v45, v37, v5
    v_and_b32 v46, v37, v6
    v_and_b32 v47, v37, v7
    v_mfma_f32_16x16x32_bf16 v[16:19], v[40:43], v[72:75], v[16:19]
    v_mfma_f32_16x16x32_bf16 v[48:51], v[40:43], v[104:107], v[48:51]
    v_and_b32 v40, v38, v4
    v_and_b32 v41, v38, v5
    v_and_b32 v42, v38, v6
    v_and_b32 v43, v38, v7
    v_mfma_f32_16x16x32_bf16 v[16:19], v[44:47], v[76:79], v[16:19]
    v_mfma_f32_16x16x32_bf16 v[48:51], v[44:47], v[108:111], v[48:51]
    v_and_b32 v44, v39, v4
    v_and_b32 v45, v39, v5
    v_and_b32 v46, v39, v6
    v_and_b32 v47, v39, v7
    v_mfma_f32_16x16x32_bf16 v[16:19], v[40:43], v[80:83], v[16:19]
    v_mfma_f32_16x16x32_bf16 v[48:51], v[40:43], v[112:115], v[48:51]
    v_mfma_f32_16x16x32_bf16 v[16:19], v[44:47], v[84:87], v[16:19]
    v_mfma_f32_16x16x32_bf16 v[48:51], v[44:47], v[116:119], v[48:51]
    v_add_f32_dpp v122, v122, v122 row_ror:4 row_mask:0xf bank_mask:0xf
    v_add_f32_dpp v123, v123, v123 row_ror:4 row_mask:0xf bank_mask:0xf
    s_nop 0
    v_add_f32_dpp v122, v122, v122 row_ror:2 row_mask:0xf bank_mask:0xf
    v_add_f32_dpp v123, v123, v123 row_ror:2 row_mask:0xf bank_mask:0xf
    s_nop 0
    v_add_f32_dpp v122, v122, v122 row_ror:1 row_mask:0xf bank_mask:0xf
    v_add_f32_dpp v123, v123, v123 row_ror:1 row_mask:0xf bank_mask:0xf
    s_nop 0
    s_mov_b64 exec, s[58:59]
    ds_add_f32 v125, v122 offset:64
    ds_add_f32 v125, v123 offset:68
    s_mov_b64 exec, -1
    v_permlane32_swap_b32 v16, v48
    v_permlane32_swap_b32 v17, v49
    v_permlane32_swap_b32 v18, v50
    v_permlane32_swap_b32 v19, v51
    s_nop 0
    v_add_f32_dpp v16, v48, v16 row_ror:8 row_mask:0xf bank_mask:0xf
    v_add_f32_dpp v17, v49, v17 row_ror:8 row_mask:0xf bank_mask:0xf
    v_add_f32_dpp v18, v50, v18 row_ror:8 row_mask:0xf bank_mask:0xf
    v_add_f32_dpp v19, v51, v19 row_ror:8 row_mask:0xf bank_mask:0xf
    s_mov_b64 exec, s[36:37]
    ds_write_b128 v22, v[16:19] offset:10496
    s_mov_b64 exec, -1
    s_cmp_eq_u32 s66, 2
    s_cbranch_scc1 L_pass_done
    v_add_u32 v22, 5120, v22
    v_mov_b32 v120, v26
    s_add_u32 s66, s66, 1
    s_cmp_eq_u32 s66, 1
    s_cbranch_scc1 L_pass
    v_mov_b32 v125, 0
    s_waitcnt lgkmcnt(0)
    s_barrier
    s_mov_b32 s3, 0
L_lw_24:
    ds_read_b32 v23, v15 offset:24
    s_add_u32 s3, s3, 1
    s_cmp_gt_u32 s3, 4194304
    s_cbranch_scc1 L_fin
    s_waitcnt lgkmcnt(0)
    v_readfirstlane_b32 s2, v23
    s_cmp_eq_u32 s2, 5
    s_cbranch_scc1 L_lw_24_ok
    s_sleep 1
    s_branch L_lw_24
L_lw_24_ok:
    s_mov_b32 s3, 0
L_hb_25:
    buffer_load_dwordx4 v[32:35], v29, s[44:47], s62 offen sc1
    buffer_load_dwordx4 v[36:39], v29, s[44:47], s63 offen sc1
    buffer_load_dwordx4 v[40:43], v29, s[44:47], s64 offen sc1
    buffer_load_dwordx4 v[44:47], v29, s[44:47], s65 offen sc1
L_hb_25_in:
    s_add_u32 s3, s3, 1
    s_cmp_gt_u32 s3, 524288
    s_waitcnt vmcnt(2)
    v_pk_add_f32 v[32:33], v[32:33], v[36:37]
    v_pk_add_f32 v[34:35], v[34:35], v[38:39]
    s_waitcnt vmcnt(1)
    v_pk_add_f32 v[32:33], v[32:33], v[40:41]
    v_pk_add_f32 v[34:35], v[34:35], v[42:43]
    s_waitcnt vmcnt(0)
    v_pk_add_f32 v[32:33], v[32:33], v[44:45]
    v_pk_add_f32 v[34:35], v[34:35], v[46:47]
    s_nop 1
    v_permlane32_swap_b32 v32, v34
    v_permlane32_swap_b32 v33, v35
    v_pk_add_f32 v[32:33], v[32:33], v[34:35]
    s_nop 1
    v_permlane16_swap_b32 v32, v33
    v_add_f32 v121, v32, v33
    v_cmp_u_f32 vcc, v121, v121
    s_cbranch_scc1 L_hb_25_ok
    s_cbranch_vccnz L_hb_25
L_hb_25_ok:
    v_fma_f32 v120, v121, v30, v31
    s_branch L_pass
L_pass_done:
    s_waitcnt lgkmcnt(0)
    s_barrier
    s_lshl_b32 s62, s35, 8
    s_add_u32 s62, s62, 201728
    s_add_u32 s63, s62, 10240
    s_add_u32 s64, s62, 20480
    s_add_u32 s65, s62, 30720
    s_add_u32 s66, s62, 40960
    s_add_u32 s67, s62, 51200
    s_add_u32 s68, s62, 61440
    s_mov_b32 s52, s26
    s_mov_b32 s53, s27
    s_mov_b32 s36, -1
    s_mov_b32 s37, 0xffff
    v_mov_b32 v56, 0
    v_mov_b32 v57, 0
    v_mov_b32 v58, 0
    v_mov_b32 v59, 0
    v_mov_b32 v84, 0
    v_mov_b32 v85, 0
    v_mov_b32 v86, 0
    v_mov_b32 v87, 0
    s_cmp_eq_u32 s34, s35
    s_cbranch_scc0 L_fin
    s_mov_b32 s3, 0
L_gb:
    buffer_load_ushort v28, v20, s[44:47], s42 offen offset:1280 sc1
    s_add_u32 s3, s3, 1
    s_cmp_gt_u32 s3, 4194304
    s_cbranch_scc1 L_fin
    s_waitcnt vmcnt(0)
    v_cmp_eq_u32 vcc, 0xffff, v28
    s_cbranch_vccnz L_gb
    v_lshlrev_b32 v28, 16, v28
    s_mov_b32 s3, 0
L_hc_26:
    buffer_load_dwordx4 v[32:35], v29, s[44:47], s62 offen sc1
    buffer_load_dwordx4 v[36:39], v29, s[44:47], s63 offen sc1
    buffer_load_dwordx4 v[40:43], v29, s[44:47], s64 offen sc1
    buffer_load_dwordx4 v[44:47], v29, s[44:47], s65 offen sc1
    buffer_load_dwordx4 v[48:51], v29, s[44:47], s66 offen sc1
    buffer_load_dwordx4 v[52:55], v29, s[44:47], s67 offen sc1
    s_mov_b64 exec, s[36:37]
    buffer_load_dwordx4 v[56:59], v29, s[44:47], s68 offen sc1
    s_mov_b64 exec, -1
L_hc_26_in:
    s_add_u32 s3, s3, 1
    s_cmp_gt_u32 s3, 524288
    s_waitcnt vmcnt(5)
    v_pk_add_f32 v[32:33], v[32:33], v[36:37]
    v_pk_add_f32 v[34:35], v[34:35], v[38:39]
    s_waitcnt vmcnt(4)
    v_pk_add_f32 v[32:33], v[32:33], v[40:41]
    v_pk_add_f32 v[34:35], v[34:35], v[42:43]
    s_waitcnt vmcnt(3)
    v_pk_add_f32 v[32:33], v[32:33], v[44:45]
    v_pk_add_f32 v[34:35], v[34:35], v[46:47]
    s_waitcnt vmcnt(2)
    v_pk_add_f32 v[32:33], v[32:33], v[48:49]
    v_pk_add_f32 v[34:35], v[34:35], v[50:51]
    s_waitcnt vmcnt(1)
    v_pk_add_f32 v[32:33], v[32:33], v[52:53]
    v_pk_add_f32 v[34:35], v[34:35], v[54:55]
    s_waitcnt vmcnt(0)
    v_pk_add_f32 v[32:33], v[32:33], v[56:57]
    v_pk_add_f32 v[34:35], v[34:35], v[58:59]
    s_nop 1
    v_permlane32_swap_b32 v32, v34
    v_permlane32_swap_b32 v33, v35
    v_pk_add_f32 v[32:33], v[32:33], v[34:35]
    s_nop 1
    v_permlane16_swap_b32 v32, v33
    v_add_f32 v120, v32, v33
    v_cmp_u_f32 vcc, v120, v120
    s_cbranch_scc1 L_hc_26_ok
    s_cbranch_vccnz L_hc_26
L_hc_26_ok:
    v_cvt_pk_bf16_f32 v120, v120, v120
    v_and_b32 v120, 0xffff0000, v120
    v_mul_f32 v120, v28, v120
    v_cvt_pk_bf16_f32 v120, v120, v120
    v_and_b32 v120, 0xffff0000, v120
    v_add_f32 v120, v126, v120
    v_cvt_pk_bf16_f32 v120, v120, v120
    buffer_store_short v120, v20, s[52:55], 0 offen
    s_cmp_lg_u32 s34, 0
    s_cbranch_scc1 L_notag
    s_add_u32 s61, s61, 2654435769
    v_mov_b32 v121, s61
    s_mov_b32 s40, 44032
    s_mov_b64 exec, 1
    buffer_store_dword v121, v15, s[44:47], s40 offen sc1
L_notag:
    s_branch L_fin
L_sec_svc2_27:
    v_and_b32 v12, 1, v0
    v_lshlrev_b32 v12, 4, v12
    v_mov_b32 v13, 0xffff
    v_lshlrev_b32 v13, v12, v13
    v_bfe_u32 v12, v0, 1, 2
    v_cmp_eq_u32 vcc, 0, v12
    s_nop 1
    v_cndmask_b32 v4, 0, v13, vcc
    v_cmp_eq_u32 vcc, 1, v12
    s_nop 1
    v_cndmask_b32 v5, 0, v13, vcc
    v_cmp_eq_u32 vcc, 2, v12
    s_nop 1
    v_cndmask_b32 v6, 0, v13, vcc
    v_cmp_eq_u32 vcc, 3, v12
    s_nop 1
    v_cndmask_b32 v7, 0, v13, vcc
    v_lshlrev_b32 v14, 2, v0
    v_lshlrev_b32 v17, 5, v1
    v_lshl_add_u32 v17, v2, 4, v17
    s_mul_i32 s40, s34, 2560
    s_lshl_b32 s2, s35, 9
    s_add_u32 s40, s40, s2
    s_add_u32 s40, s40, 201728
    s_mov_b32 s41, 0xbdd2d3e8
    v_mov_b32 v16, 0xc0135761
    s_mov_b32 s36, -1
    s_mov_b32 s37, 0
    s_mov_b32 s44, s30
    s_mov_b32 s45, s31
    s_mov_b32 s46, 270848
    s_mov_b32 s47, 0x20000
    v_mov_b32 v15, 0
    v_mov_b32 v52, 0x3acccccd
    v_mov_b32 v53, 0x3727c5ac
    ds_read2st64_b32 v[20:21], v14 offset0:41 offset1:42
    ds_read2st64_b32 v[22:23], v14 offset0:43 offset1:44
    ds_read2st64_b32 v[24:25], v14 offset0:45 offset1:46
    ds_read2st64_b32 v[26:27], v14 offset0:47 offset1:48
    ds_read2st64_b32 v[28:29], v14 offset0:49 offset1:50
    ds_read2st64_b32 v[30:31], v14 offset0:51 offset1:52
    ds_read2st64_b32 v[32:33], v14 offset0:53 offset1:54
    ds_read2st64_b32 v[34:35], v14 offset0:55 offset1:56
    ds_read2st64_b32 v[36:37], v14 offset0:57 offset1:58
    ds_read2st64_b32 v[38:39], v14 offset0:59 offset1:60
    s_waitcnt lgkmcnt(0)
    v_pk_add_f32 v[20:21], v[20:21], v[22:23]
    v_pk_add_f32 v[20:21], v[20:21], v[24:25]
    v_pk_add_f32 v[20:21], v[20:21], v[26:27]
    v_pk_add_f32 v[20:21], v[20:21], v[28:29]
    v_pk_add_f32 v[20:21], v[20:21], v[30:31]
    v_pk_add_f32 v[20:21], v[20:21], v[32:33]
    v_pk_add_f32 v[20:21], v[20:21], v[34:35]
    v_pk_add_f32 v[20:21], v[20:21], v[36:37]
    v_pk_add_f32 v[48:49], v[20:21], v[38:39]
    ds_read2st64_b32 v[20:21], v14 offset0:61 offset1:62
    ds_read2st64_b32 v[22:23], v14 offset0:63 offset1:64
    ds_read2st64_b32 v[24:25], v14 offset0:65 offset1:66
    ds_read2st64_b32 v[26:27], v14 offset0:67 offset1:68
    ds_read2st64_b32 v[28:29], v14 offset0:69 offset1:70
    ds_read2st64_b32 v[30:31], v14 offset0:71 offset1:72
    ds_read2st64_b32 v[32:33], v14 offset0:73 offset1:74
    ds_read2st64_b32 v[34:35], v14 offset0:75 offset1:76
    ds_read2st64_b32 v[36:37], v14 offset0:77 offset1:78
    ds_read2st64_b32 v[38:39], v14 offset0:79 offset1:80
    s_waitcnt lgkmcnt(0)
    v_pk_add_f32 v[20:21], v[20:21], v[22:23]
    v_pk_add_f32 v[20:21], v[20:21], v[24:25]
    v_pk_add_f32 v[20:21], v[20:21], v[26:27]
    v_pk_add_f32 v[20:21], v[20:21], v[28:29]
    v_pk_add_f32 v[20:21], v[20:21], v[30:31]
    v_pk_add_f32 v[20:21], v[20:21], v[32:33]
    v_pk_add_f32 v[20:21], v[20:21], v[34:35]
    v_pk_add_f32 v[20:21], v[20:21], v[36:37]
    v_pk_add_f32 v[50:51], v[20:21], v[38:39]
    s_barrier
    ds_read_b64 v[54:55], v15 offset:64
    ds_read2st64_b32 v[20:21], v14 offset0:81 offset1:82
    ds_read2st64_b32 v[22:23], v14 offset0:83 offset1:84
    ds_read2st64_b32 v[24:25], v14 offset0:85 offset1:86
    ds_read2st64_b32 v[26:27], v14 offset0:87 offset1:88
    ds_read2st64_b32 v[28:29], v14 offset0:89 offset1:90
    ds_read2st64_b32 v[30:31], v14 offset0:91 offset1:92
    ds_read2st64_b32 v[32:33], v14 offset0:93 offset1:94
    ds_read2st64_b32 v[34:35], v14 offset0:95 offset1:96
    ds_read2st64_b32 v[36:37], v14 offset0:97 offset1:98
    ds_read2st64_b32 v[38:39], v14 offset0:99 offset1:100
    s_waitcnt lgkmcnt(10)
    v_mul_f32 v54, v54, v52
    v_fma_f32 v55, v55, v52, v53
    v_fma_f32 v55, -v54, v54, v55
    v_max_f32 v55, v53, v55
    v_pk_mul_f32 v[46:47], v[48:49], v[54:55] op_sel_hi:[1,0]
    v_rsq_f32 v55, v55
    s_waitcnt lgkmcnt(8)
    v_pk_add_f32 v[20:21], v[20:21], v[22:23]
    s_waitcnt lgkmcnt(7)
    v_pk_add_f32 v[20:21], v[20:21], v[24:25]
    s_waitcnt lgkmcnt(6)
    v_pk_add_f32 v[20:21], v[20:21], v[26:27]
    s_waitcnt lgkmcnt(5)
    v_pk_add_f32 v[20:21], v[20:21], v[28:29]
    s_waitcnt lgkmcnt(4)
    v_pk_add_f32 v[20:21], v[20:21], v[30:31]
    s_waitcnt lgkmcnt(3)
    v_pk_add_f32 v[20:21], v[20:21], v[32:33]
    s_waitcnt lgkmcnt(2)
    v_pk_add_f32 v[20:21], v[20:21], v[34:35]
    s_waitcnt lgkmcnt(1)
    v_pk_add_f32 v[20:21], v[20:21], v[36:37]
    s_waitcnt lgkmcnt(0)
    v_pk_add_f32 v[20:21], v[20:21], v[38:39]
    v_pk_add_f32 v[20:21], v[20:21], v[46:47] neg_lo:[0,1] neg_hi:[0,1]
    v_pk_fma_f32 v[20:21], v[20:21], v[54:55], v[50:51] op_sel:[0,1,0] op_sel_hi:[1,1,1]
    v_mul_f32 v23, v20, v20
    v_fma_f32 v23, s41, v23, v16
    v_mul_f32 v23, v23, v20
    v_exp_f32 v23, v23
    s_nop 0
    v_add_f32 v23, 1.0, v23
    v_rcp_f32 v24, v23
    v_mul_f32 v26, v20, v21
    v_mul_f32 v26, v26, v24
    v_cvt_pk_bf16_f32 v26, v26, v26
    s_nop 1
    v_and_b32_dpp v40, v26, v4 row_newbcast:0 row_mask:0xf bank_mask:0xf
    v_and_b32_dpp v41, v26, v5 row_newbcast:0 row_mask:0xf bank_mask:0xf
    v_and_b32_dpp v42, v26, v6 row_newbcast:0 row_mask:0xf bank_mask:0xf
    v_and_b32_dpp v43, v26, v7 row_newbcast:0 row_mask:0xf bank_mask:0xf
    v_and_b32_dpp v44, v26, v4 row_newbcast:1 row_mask:0xf bank_mask:0xf
    v_and_b32_dpp v45, v26, v5 row_newbcast:1 row_mask:0xf bank_mask:0xf
    v_and_b32_dpp v46, v26, v6 row_newbcast:1 row_mask:0xf bank_mask:0xf
    v_and_b32_dpp v47, v26, v7 row_newbcast:1 row_mask:0xf bank_mask:0xf
    s_waitcnt vmcnt(15)
    v_mfma_f32_16x16x32_bf16 v[36:39], v[40:43], v[56:59], 0
    v_and_b32_dpp v40, v26, v4 row_newbcast:2 row_mask:0xf bank_mask:0xf
    v_and_b32_dpp v41, v26, v5 row_newbcast:2 row_mask:0xf bank_mask:0xf
    v_and_b32_dpp v42, v26, v6 row_newbcast:2 row_mask:0xf bank_mask:0xf
    v_and_b32_dpp v43, v26, v7 row_newbcast:2 row_mask:0xf bank_mask:0xf
    s_waitcnt vmcnt(14)
    v_mfma_f32_16x16x32_bf16 v[36:39], v[44:47], v[60:63], v[36:39]
    v_and_b32_dpp v44, v26, v4 row_newbcast:3 row_mask:0xf bank_mask:0xf
    v_and_b32_dpp v45, v26, v5 row_newbcast:3 row_mask:0xf bank_mask:0xf
    v_and_b32_dpp v46, v26, v6 row_newbcast:3 row_mask:0xf bank_mask:0xf
    v_and_b32_dpp v47, v26, v7 row_newbcast:3 row_mask:0xf bank_mask:0xf
    s_waitcnt vmcnt(13)
    v_mfma_f32_16x16x32_bf16 v[36:39], v[40:43], v[64:67], v[36:39]
    v_and_b32_dpp v40, v26, v4 row_newbcast:4 row_mask:0xf bank_mask:0xf
    v_and_b32_dpp v41, v26, v5 row_newbcast:4 row_mask:0xf bank_mask:0xf
    v_and_b32_dpp v42, v26, v6 row_newbcast:4 row_mask:0xf bank_mask:0xf
    v_and_b32_dpp v43, v26, v7 row_newbcast:4 row_mask:0xf bank_mask:0xf
    s_waitcnt vmcnt(12)
    v_mfma_f32_16x16x32_bf16 v[36:39], v[44:47], v[68:71], v[36:39]
    v_and_b32_dpp v44, v26, v4 row_newbcast:5 row_mask:0xf bank_mask:0xf
    v_and_b32_dpp v45, v26, v5 row_newbcast:5 row_mask:0xf bank_mask:0xf
    v_and_b32_dpp v46, v26, v6 row_newbcast:5 row_mask:0xf bank_mask:0xf
    v_and_b32_dpp v47, v26, v7 row_newbcast:5 row_mask:0xf bank_mask:0xf
    s_waitcnt vmcnt(11)
    v_mfma_f32_16x16x32_bf16 v[36:39], v[40:43], v[72:75], v[36:39]
    v_and_b32_dpp v40, v26, v4 row_newbcast:6 row_mask:0xf bank_mask:0xf
    v_and_b32_dpp v41, v26, v5 row_newbcast:6 row_mask:0xf bank_mask:0xf
    v_and_b32_dpp v42, v26, v6 row_newbcast:6 row_mask:0xf bank_mask:0xf
    v_and_b32_dpp v43, v26, v7 row_newbcast:6 row_mask:0xf bank_mask:0xf
    s_waitcnt vmcnt(10)
    v_mfma_f32_16x16x32_bf16 v[36:39], v[44:47], v[76:79], v[36:39]
    v_and_b32_dpp v44, v26, v4 row_newbcast:7 row_mask:0xf bank_mask:0xf
    v_and_b32_dpp v45, v26, v5 row_newbcast:7 row_mask:0xf bank_mask:0xf
    v_and_b32_dpp v46, v26, v6 row_newbcast:7 row_mask:0xf bank_mask:0xf
    v_and_b32_dpp v47, v26, v7 row_newbcast:7 row_mask:0xf bank_mask:0xf
    s_waitcnt vmcnt(9)
    v_mfma_f32_16x16x32_bf16 v[36:39], v[40:43], v[80:83], v[36:39]
    v_and_b32_dpp v40, v26, v4 row_newbcast:8 row_mask:0xf bank_mask:0xf
    v_and_b32_dpp v41, v26, v5 row_newbcast:8 row_mask:0xf bank_mask:0xf
    v_and_b32_dpp v42, v26, v6 row_newbcast:8 row_mask:0xf bank_mask:0xf
    v_and_b32_dpp v43, v26, v7 row_newbcast:8 row_mask:0xf bank_mask:0xf
    s_waitcnt vmcnt(8)
    v_mfma_f32_16x16x32_bf16 v[36:39], v[44:47], v[84:87], v[36:39]
    v_and_b32_dpp v44, v26, v4 row_newbcast:9 row_mask:0xf bank_mask:0xf
    v_and_b32_dpp v45, v26, v5 row_newbcast:9 row_mask:0xf bank_mask:0xf
    v_and_b32_dpp v46, v26, v6 row_newbcast:9 row_mask:0xf bank_mask:0xf
    v_and_b32_dpp v47, v26, v7 row_newbcast:9 row_mask:0xf bank_mask:0xf
    s_waitcnt vmcnt(7)
    v_mfma_f32_16x16x32_bf16 v[36:39], v[40:43], v[88:91], v[36:39]
    v_and_b32_dpp v40, v26, v4 row_newbcast:10 row_mask:0xf bank_mask:0xf
    v_and_b32_dpp v41, v26, v5 row_newbcast:10 row_mask:0xf bank_mask:0xf
    v_and_b32_dpp v42, v26, v6 row_newbcast:10 row_mask:0xf bank_mask:0xf
    v_and_b32_dpp v43, v26, v7 row_newbcast:10 row_mask:0xf bank_mask:0xf
    s_waitcnt vmcnt(6)
    v_mfma_f32_16x16x32_bf16 v[36:39], v[44:47], v[92:95], v[36:39]
    v_and_b32_dpp v44, v26, v4 row_newbcast:11 row_mask:0xf bank_mask:0xf
    v_and_b32_dpp v45, v26, v5 row_newbcast:11 row_mask:0xf bank_mask:0xf
    v_and_b32_dpp v46, v26, v6 row_newbcast:11 row_mask:0xf bank_mask:0xf
    v_and_b32_dpp v47, v26, v7 row_newbcast:11 row_mask:0xf bank_mask:0xf
    s_waitcnt vmcnt(5)
    v_mfma_f32_16x16x32_bf16 v[36:39], v[40:43], v[96:99], v[36:39]
    v_and_b32_dpp v40, v26, v4 row_newbcast:12 row_mask:0xf bank_mask:0xf
    v_and_b32_dpp v41, v26, v5 row_newbcast:12 row_mask:0xf bank_mask:0xf
    v_and_b32_dpp v42, v26, v6 row_newbcast:12 row_mask:0xf bank_mask:0xf
    v_and_b32_dpp v43, v26, v7 row_newbcast:12 row_mask:0xf bank_mask:0xf
    s_waitcnt vmcnt(4)
    v_mfma_f32_16x16x32_bf16 v[36:39], v[44:47], v[100:103], v[36:39]
    v_and_b32_dpp v44, v26, v4 row_newbcast:13 row_mask:0xf bank_mask:0xf
    v_and_b32_dpp v45, v26, v5 row_newbcast:13 row_mask:0xf bank_mask:0xf
    v_and_b32_dpp v46, v26, v6 row_newbcast:13 row_mask:0xf bank_mask:0xf
    v_and_b32_dpp v47, v26, v7 row_newbcast:13 row_mask:0xf bank_mask:0xf
    s_waitcnt vmcnt(3)
    v_mfma_f32_16x16x32_bf16 v[36:39], v[40:43], v[104:107], v[36:39]
    v_and_b32_dpp v40, v26, v4 row_newbcast:14 row_mask:0xf bank_mask:0xf
    v_and_b32_dpp v41, v26, v5 row_newbcast:14 row_mask:0xf bank_mask:0xf
    v_and_b32_dpp v42, v26, v6 row_newbcast:14 row_mask:0xf bank_mask:0xf
    v_and_b32_dpp v43, v26, v7 row_newbcast:14 row_mask:0xf bank_mask:0xf
    s_waitcnt vmcnt(2)
    v_mfma_f32_16x16x32_bf16 v[36:39], v[44:47], v[108:111], v[36:39]
    v_and_b32_dpp v44, v26, v4 row_newbcast:15 row_mask:0xf bank_mask:0xf
    v_and_b32_dpp v45, v26, v5 row_newbcast:15 row_mask:0xf bank_mask:0xf
    v_and_b32_dpp v46, v26, v6 row_newbcast:15 row_mask:0xf bank_mask:0xf
    v_and_b32_dpp v47, v26, v7 row_newbcast:15 row_mask:0xf bank_mask:0xf
    s_waitcnt vmcnt(1)
    v_mfma_f32_16x16x32_bf16 v[36:39], v[40:43], v[112:115], v[36:39]
    s_waitcnt vmcnt(0)
    v_mfma_f32_16x16x32_bf16 v[36:39], v[44:47], v[116:119], v[36:39]
    s_mov_b64 exec, s[36:37]
    s_nop 6
    buffer_store_dwordx4 v[36:39], v17, s[44:47], s40 offen sc1
    s_branch L_fin
L_sec_svc2_30:
    v_mov_b32 v8, 0
    v_mov_b32 v9, 1
    s_mov_b32 s35, s34
    s_branch L_chk
L_echk:
    s_waitcnt lgkmcnt(0)
    s_add_u32 s98, s61, 2654435769
    s_mov_b32 s99, s98
    s_mov_b32 s35, s34
    s_mov_b32 s34, 32
    v_mov_b32 v8, 0
    v_mov_b32 v9, 1
    s_mov_b32 s3, 0
L_lw_31:
    ds_read_b32 v10, v8 offset:24
    s_add_u32 s3, s3, 1
    s_cmp_gt_u32 s3, 4194304
    s_cbranch_scc1 L_fin
    s_waitcnt lgkmcnt(0)
    v_readfirstlane_b32 s2, v10
    s_cmp_ge_u32 s2, 1
    s_cbranch_scc1 L_lw_31_ok
    s_sleep 4
    s_branch L_lw_31
L_lw_31_ok:
L_chk:
    s_and_b32 s84, s35, 7
    s_lshl_b32 s84, s84, 7
    s_add_u32 s84, s84, 43008
    s_mov_b32 s3, 0
L_clr_32:
    s_cmp_ge_u32 s3, 8
    s_cbranch_scc1 L_clr_32_g
    s_load_dwordx16 s[52:67], s[30:31], s84
    s_load_dwordx16 s[68:83], s[30:31], s84 offset:64
    s_add_u32 s84, s84, 128
    s_cmp_ge_u32 s84, 44032
    s_cbranch_scc0 L_clr_32_w
    s_sub_u32 s84, s84, 1024
    s_branch L_clr_32_w
L_clr_32_g:
    s_sleep 64
    s_load_dwordx16 s[52:67], s[30:31], s84 glc
    s_load_dwordx16 s[68:83], s[30:31], s84 offset:64 glc
L_clr_32_w:
    s_add_u32 s3, s3, 1
    s_waitcnt lgkmcnt(0)
    s_cmp_gt_u32 s3, 4194304
    s_cbranch_scc1 L_fin
    s_xor_b64 s[86:87], s[52:53], s[98:99]
    s_xor_b64 s[54:55], s[54:55], s[98:99]
    s_or_b64 s[86:87], s[86:87], s[54:55]
    s_xor_b64 s[56:57], s[56:57], s[98:99]
    s_or_b64 s[86:87], s[86:87], s[56:57]
    s_xor_b64 s[58:59], s[58:59], s[98:99]
    s_or_b64 s[86:87], s[86:87], s[58:59]
    s_xor_b64 s[60:61], s[60:61], s[98:99]
    s_or_b64 s[86:87], s[86:87], s[60:61]
    s_xor_b64 s[62:63], s[62:63], s[98:99]
    s_or_b64 s[86:87], s[86:87], s[62:63]
    s_xor_b64 s[64:65], s[64:65], s[98:99]
    s_or_b64 s[86:87], s[86:87], s[64:65]
    s_xor_b64 s[66:67], s[66:67], s[98:99]
    s_or_b64 s[86:87], s[86:87], s[66:67]
    s_xor_b64 s[68:69], s[68:69], s[98:99]
    s_or_b64 s[86:87], s[86:87], s[68:69]
    s_xor_b64 s[70:71], s[70:71], s[98:99]
    s_or_b64 s[86:87], s[86:87], s[70:71]
    s_xor_b64 s[72:73], s[72:73], s[98:99]
    s_or_b64 s[86:87], s[86:87], s[72:73]
    s_xor_b64 s[74:75], s[74:75], s[98:99]
    s_or_b64 s[86:87], s[86:87], s[74:75]
    s_xor_b64 s[76:77], s[76:77], s[98:99]
    s_or_b64 s[86:87], s[86:87], s[76:77]
    s_xor_b64 s[78:79], s[78:79], s[98:99]
    s_or_b64 s[86:87], s[86:87], s[78:79]
    s_xor_b64 s[80:81], s[80:81], s[98:99]
    s_or_b64 s[86:87], s[86:87], s[80:81]
    s_xor_b64 s[82:83], s[82:83], s[98:99]
    s_or_b64 s[86:87], s[86:87], s[82:83]
    s_cbranch_scc0 L_clr_32_ok
    s_sleep 16
    s_branch L_clr_32
L_clr_32_ok:
    ds_write_b32 v8, v9 offset:0
    s_cmp_eq_u32 s34, 32
    s_cbranch_scc0 L_chk2
    s_mov_b32 s34, s35
    s_cmp_lt_u32 s34, 10
    s_cbranch_scc1 L_probe0
    s_branch L_fin
L_chk2:
    s_cmp_ge_u32 s34, 27
    s_cbranch_scc1 L_fin
    s_mov_b32 s52, s30
    s_mov_b32 s53, s31
    s_mov_b32 s54, 270848
    s_mov_b32 s55, 0x20000
L_probe0:
    v_mov_b32 v8, 0
    v_mov_b32 v9, 1
    s_mul_i32 s40, s34, 3072
    s_add_u32 s40, s40, 62464
    s_mov_b32 s3, 0
L_probe_28:
    s_load_dword s52, s[30:31], s40 offset:1536 glc
    s_load_dword s53, s[30:31], s40 offset:512 glc
    s_load_dword s54, s[30:31], s40 offset:2560 glc
    s_add_u32 s3, s3, 1
    s_waitcnt lgkmcnt(0)
    s_cmp_gt_u32 s3, 4194304
    s_cbranch_scc1 L_fin
    s_and_b32 s52, s52, s53
    s_and_b32 s52, s52, s54
    s_cmp_eq_u32 s52, -1
    s_cbranch_scc0 L_probe_28_ok
    s_sleep 6
    s_branch L_probe_28
L_probe_28_ok:
    ds_write_b32 v8, v9 offset:4
    s_branch L_fin
L_fin:
L_end:
    s_endpgm

.section .rodata,"a"
.p2align 6
.amdhsa_kernel adaLN_cond__gqa_block_cached__glu_gated_geglu__decode_kernel
  .amdhsa_next_free_vgpr 128
  .amdhsa_next_free_sgpr 102
  .amdhsa_accum_offset 128
  .amdhsa_group_segment_fixed_size 0
  .amdhsa_kernarg_size 112
  .amdhsa_user_sgpr_count 2
  .amdhsa_user_sgpr_kernarg_segment_ptr 1
  .amdhsa_system_sgpr_workgroup_id_x 1
  .amdhsa_float_denorm_mode_32 3
  .amdhsa_float_denorm_mode_16_64 3
.end_amdhsa_kernel
```
